```python
import torch

def _softmax(x, axis=-1):
    return torch.softmax(x, dim=axis)
def _gelu(x):
    return torch.nn.functional.gelu(x, approximate="tanh")
def _silu(x):
    return torch.nn.functional.silu(x)
def _sigmoid(x):
    return torch.sigmoid(x)
def _layernorm(x, axis=-1, eps=1e-5):
    m = x.mean(dim=axis, keepdim=True)
    v = x.var(dim=axis, keepdim=True, unbiased=False)
    return (x - m) / torch.sqrt(v + eps)
def _scatter_add(tgt, idx, src, axis=0):
    return tgt.clone().index_add_(axis, idx, src)
def _segment_sum(src, seg, n):
    out = torch.zeros((n,) + src.shape[1:], dtype=src.dtype)
    return out.index_add_(0, seg, src)
def _pad(x, pw):
    flat = tuple(v for pair in reversed(pw) for v in pair)
    return torch.nn.functional.pad(x, flat)

kernel_name = 'sequential_preLN__sliding_block_cached__swiglu_ffn__decode'

def setup_inputs():

    _w = (lambda a: (lambda t: t.to(torch.bfloat16) if t.is_floating_point() else t)(torch.as_tensor(a)))
    def _A_setup():
        B, Sq, D = 2, 1, 640
        Hq, Hkv, Sk, Dh = 32, 32, 4096, 128
        assert Hq % Hkv == 0, (Hq, Hkv)
        return {
            "x": _w((lambda *s: torch.randn(*s, dtype=torch.bfloat16) * 0.05)(B, Sq, D)),
            "k_cache": _w((lambda *s: torch.randn(*s, dtype=torch.bfloat16) * 3.2)(B, Hkv, Sk, Dh)),
            "v_cache": _w((lambda *s: torch.randn(*s, dtype=torch.bfloat16) * 0.4)(B, Hkv, Sk, Dh)),
            "wq": _w((lambda *s: torch.randn(*s, dtype=torch.bfloat16) * 3.2)(D, Hq * Dh) * (D ** -0.5)),
            "wo": _w((lambda *s: torch.randn(*s, dtype=torch.bfloat16) * 0.4)(Hq * Dh, D) * ((Hq * Dh) ** -0.5)),
        }
    _A_in = _A_setup()

    def _B_setup():
        B, S, D, F = 2, 1, 640, 1728
        return {
            "x": _w((lambda *s: torch.randn(*s, dtype=torch.bfloat16) * 0.05)(B, S, D)),
            "w_gate": _w((lambda *s: torch.randn(*s, dtype=torch.bfloat16) * 0.05)(D, F)),
            "w_up": _w((lambda *s: torch.randn(*s, dtype=torch.bfloat16) * 0.05)(D, F)),
            "w_down": _w((lambda *s: torch.randn(*s, dtype=torch.bfloat16) * 0.05)(F, D)),
        }
    _B_in = _B_setup()

    return {
        "A_x": _A_in["x"],
        "A_k_cache": _A_in["k_cache"],
        "A_v_cache": _A_in["v_cache"],
        "A_wq": _A_in["wq"],
        "A_wo": _A_in["wo"],
        "B_x": _B_in["x"],
        "B_w_gate": _B_in["w_gate"],
        "B_w_up": _B_in["w_up"],
        "B_w_down": _B_in["w_down"],
    }

def reference(A_x, A_k_cache, A_v_cache, A_wq, A_wo, B_x, B_w_gate, B_w_up, B_w_down):
    def _A_ref(x, k_cache, v_cache, wq, wo):
        B, Sq, D = x.shape
        Hq, Dh = 32, 128
        Hkv, Sk = k_cache.shape[1], k_cache.shape[2]
        W = min(4096, max(256, Sk // 4))
        rep = Hq // Hkv
        q = (lambda x, *d: x.permute(*d))((x @ wq).reshape(B, Sq, Hq, Dh), 0, 2, 1, 3)
        k = (lambda x, n, axis: torch.repeat_interleave(x, n, dim=axis))(k_cache[:, :, Sk - W:, :], rep, axis=1)
        v = (lambda x, n, axis: torch.repeat_interleave(x, n, dim=axis))(v_cache[:, :, Sk - W:, :], rep, axis=1)
        scores = torch.einsum("bhqd,bhkd->bhqk", q, k) * (Dh ** -0.5)
        p = _softmax(scores, axis=-1)
        o = torch.einsum("bhqk,bhkd->bhqd", p, v)
        return (lambda x, *d: x.permute(*d))(o, 0, 2, 1, 3).reshape(B, Sq, Hq * Dh) @ wo

    def _B_ref(x, w_gate, w_up, w_down):
        g = _silu(x @ w_gate)
        u = x @ w_up
        return (g * u) @ w_down

    x = A_x
    h = x + _A_ref(_layernorm(x, axis=-1), A_k_cache, A_v_cache, A_wq, A_wo)
    h2 = h + _B_ref(_layernorm(h, axis=-1), B_w_gate, B_w_up, B_w_down)
    return h2
```

```asm
; @launch grid=(256,1,1) block=(640,1,1) lds=135168
.amdgcn_target "amdgcn-amd-amdhsa--gfx950"
.text
.globl sequential_preLN__sliding_block_cached__swiglu_ffn__decode_kernel
.p2align 8
.type sequential_preLN__sliding_block_cached__swiglu_ffn__decode_kernel,@function
sequential_preLN__sliding_block_cached__swiglu_ffn__decode_kernel:
L_start:
    s_load_dwordx16 s[4:19], s[0:1], 0
    s_load_dwordx8 s[20:27], s[0:1], 64
    v_lshrrev_b32 v2, 6, v0
    v_and_b32 v1, 63, v0
    v_readfirstlane_b32 s29, v2
    s_cmp_ge_u32 s2, 8
    s_cbranch_scc1 L_nopf
    s_getpc_b64 s[40:41]
    v_lshlrev_b32 v3, 4, v0
    global_load_dwordx4 v[152:155], v3, s[40:41]
    s_add_u32 s40, s40, 10240
    s_addc_u32 s41, s41, 0
    global_load_dwordx4 v[152:155], v3, s[40:41]
L_nopf:
    s_cmp_ge_u32 s2, 256
    s_cbranch_scc1 L_end
    s_sub_u32 s60, s2, 1
    s_and_b32 s60, s60, 7
    s_cbranch_scc0 L_shead
    s_cmp_ge_u32 s29, 2
    s_cbranch_scc1 L_awave
    v_lshlrev_b32 v5, 2, v1
    s_mul_i32 s34, s29, 1280
    v_add_u32 v6, s34, v5
    v_mov_b32 v7, 0
    ds_write_b32 v5, v7 offset:3072
    ds_write_b32 v5, v7 offset:3328
    s_waitcnt lgkmcnt(0)
    global_load_dword v8, v6, s[4:5] offset:0
    global_load_dword v9, v6, s[4:5] offset:256
    global_load_dword v10, v6, s[4:5] offset:512
    global_load_dword v11, v6, s[4:5] offset:768
    global_load_dword v12, v6, s[4:5] offset:1024
    s_load_dword s28, s[26:27], 0
    s_barrier
    s_branch L_helper
L_awave:
    s_lshr_b32 s31, s2, 3
    s_mul_i32 s61, s31, 37
    s_lshr_b32 s61, s61, 8
    s_mul_i32 s33, s61, 7
    s_sub_u32 s31, s31, s33
    s_sub_u32 s33, s60, 1
    s_cmp_eq_u32 s61, 4
    s_cselect_b32 s61, s31, s61
    s_cselect_b32 s31, s33, s31
    s_cselect_b32 s60, 0, s60
    s_lshl_b32 s30, s61, 3
    s_add_u32 s30, s30, s60
    s_sub_u32 s29, s29, 2
    v_lshrrev_b32 v6, 4, v1
    v_and_b32 v7, 15, v1
    s_lshl_b32 s34, s29, 1
    s_and_b32 s34, s34, 4
    v_or_b32 v8, s34, v6
    v_lshlrev_b32 v8, 1, v8
    v_xor_b32 v8, v8, v7
    v_lshlrev_b32 v8, 4, v8
    v_lshl_add_u32 v9, v6, 13, v8
    s_mul_i32 s34, s31, 24
    s_add_u32 s34, s34, s29
    s_lshl_b32 s34, s34, 7
    s_add_u32 s34, s34, s30
    s_lshl_b32 s34, s34, 8
    s_lshl_b32 s37, s29, 10
    s_add_u32 s38, s37, 8192
    s_mov_b32 m0, s38
    v_lshlrev_b32 v3, 4, v1
    s_lshr_b32 s35, s31, 1
    s_lshl_b32 s35, s35, 9
    s_and_b32 s36, s31, 1
    s_add_u32 s35, s35, s36
    s_lshl_b32 s35, s35, 3
    s_add_u32 s35, s35, s29
    s_lshl_b32 s35, s35, 5
    s_lshr_b32 s39, s29, 2
    s_lshl_b32 s39, s39, 12
    s_and_b32 s36, s29, 3
    s_add_u32 s39, s39, s36
    s_add_u32 s39, s39, 16
    s_lshl_b32 s39, s39, 5
    s_cmp_eq_u32 s31, 4
    s_cselect_b32 s35, s39, s35
    s_sub_u32 s39, s31, 5
    s_lshl_b32 s39, s39, 17
    s_mul_i32 s36, s29, 48
    s_add_u32 s39, s39, s36
    s_add_u32 s39, s39, 640
    s_cmp_ge_u32 s31, 5
    s_cselect_b32 s35, s39, s35
    s_lshl_b32 s36, s30, 12
    s_add_u32 s35, s35, s36
    s_add_u32 s35, s35, 3072
    s_lshl_b32 s35, s35, 8
    s_waitcnt lgkmcnt(0)
    s_add_u32 s10, s10, s34
    s_addc_u32 s11, s11, 0
    global_load_lds_dwordx4 v9, s[10:11] nt
    s_add_u32 s38, s38, 8192
    s_mov_b32 m0, s38
    s_add_u32 s10, s10, 262144
    s_addc_u32 s11, s11, 0
    global_load_lds_dwordx4 v9, s[10:11] nt
    s_cmp_eq_u32 s31, 6
    s_cbranch_scc1 L_no_d2
    s_add_u32 s38, s38, 8192
    s_mov_b32 m0, s38
    s_add_u32 s10, s10, 262144
    s_addc_u32 s11, s11, 0
    global_load_lds_dwordx4 v9, s[10:11] nt
L_no_d2:
    s_add_u32 s6, s6, s35
    s_addc_u32 s7, s7, 0
    s_barrier
    global_load_dwordx4 v[72:75], v3, s[6:7] offset:0 nt
    global_load_dwordx4 v[76:79], v3, s[6:7] offset:1024 nt
    global_load_dwordx4 v[80:83], v3, s[6:7] offset:2048 nt
    s_load_dword s28, s[26:27], 0
    s_mov_b32 s59, 0
    s_add_u32 s8, s8, s35
    s_addc_u32 s9, s9, 0
    v_add_u32 v4, 4096, v3
    v_add_u32 v5, 8192, v3
    s_lshl_b32 s34, s29, 2
    v_mov_b32 v38, s34
    v_and_b32 v15, 1, v7
    v_lshlrev_b32 v15, 4, v15
    v_mov_b32 v16, 0xffff
    v_lshlrev_b32 v16, v15, v16
    v_lshrrev_b32 v15, 1, v7
    v_cmp_eq_u32 s[48:49], 0, v15
    v_cmp_eq_u32 s[50:51], 1, v15
    v_cmp_eq_u32 s[52:53], 2, v15
    v_cmp_eq_u32 s[54:55], 3, v15
    s_nop 0
    v_cndmask_b32 v32, 0, v16, s[48:49]
    v_cndmask_b32 v33, 0, v16, s[50:51]
    v_cndmask_b32 v34, 0, v16, s[52:53]
    v_cndmask_b32 v35, 0, v16, s[54:55]
    s_lshr_b32 s39, s29, 2
    s_cmp_eq_u32 s31, 4
    s_cselect_b32 s39, s39, 0
    s_lshl_b32 s34, s39, 8
    v_lshlrev_b32 v36, 4, v7
    v_add_u32 v36, s34, v36
    s_lshl_b32 s34, s39, 4
    v_mov_b32 v39, s34
    v_lshlrev_b32 v37, 5, v7
    v_lshl_add_u32 v37, v6, 4, v37
    s_lshl_b32 s34, s29, 9
    v_add_u32 v37, s34, v37
    s_lshl_b32 s34, s29, 4
    v_mov_b32 v41, s34
    v_mov_b32 v42, 1
    s_waitcnt vmcnt(3)
    ds_write_b32 v38, v42 offset:3072
    s_cmp_ge_u32 s31, 5
    s_cbranch_scc1 L_att_plain
    s_waitcnt vmcnt(2)
    s_cmp_eq_u32 s60, 0
    s_cbranch_scc1 L_dw_1
    s_waitcnt vmcnt(1)
L_dw_1:
    global_load_dwordx4 v[84:87], v3, s[6:7] offset:3072 nt
    v_lshrrev_b32 v40, 2, v1
    v_mul_u32_u24 v40, 1280, v40
    v_and_b32 v10, 3, v1
    v_lshl_add_u32 v40, v10, 4, v40
    s_lshl_b32 s34, s60, 3
    s_add_u32 s34, s34, s29
    s_mul_i32 s34, s34, 20480
    s_mul_i32 s35, s61, 5
    s_add_u32 s35, s35, s31
    s_lshl_b32 s35, s35, 6
    s_add_u32 s34, s34, s35
    s_add_u32 s12, s12, s34
    s_addc_u32 s13, s13, 0
    s_add_u32 s38, s37, 32768
    s_lshl_b32 s34, s60, 14
    s_lshl_b32 s35, s29, 11
    s_add_u32 s34, s34, s35
    s_add_u32 s34, s34, 327680
    v_add_u32 v8, s34, v3
    s_lshl_b32 s34, s60, 12
    s_lshl_b32 s35, s29, 9
    s_add_u32 s34, s34, s35
    s_add_u32 s34, s34, 753664
    s_add_u32 s56, s26, s34
    s_addc_u32 s57, s27, 0
    v_and_b32 v10, 31, v1
    v_lshlrev_b32 v10, 2, v10
    v_lshrrev_b32 v11, 5, v1
    v_lshl_add_u32 v10, v11, 1, v10
    s_and_b32 s34, s29, 1
    s_lshl_b32 s34, s34, 10
    s_lshr_b32 s35, s29, 1
    s_lshl_b32 s35, s35, 7
    s_add_u32 s34, s34, s35
    v_add_u32 v10, s34, v10
    s_waitcnt lgkmcnt(0)
    s_add_u32 s28, s28, 2654435769
    s_and_b32 s44, s28, 0xff
    s_bfe_u32 s45, s28, 0x80008
    s_bfe_u32 s46, s28, 0x80010
    s_lshr_b32 s47, s28, 24
    s_waitcnt vmcnt(2)
    s_cmp_eq_u32 s60, 0
    s_cbranch_scc1 L_dw_2
    s_waitcnt vmcnt(1)
L_dw_2:
    global_load_dwordx4 v[88:91], v4, s[6:7] offset:0 nt
    s_waitcnt vmcnt(2)
    s_cmp_eq_u32 s60, 0
    s_cbranch_scc1 L_dw_3
    s_waitcnt vmcnt(1)
L_dw_3:
    global_load_dwordx4 v[92:95], v4, s[6:7] offset:1024 nt
    s_waitcnt vmcnt(2)
    s_cmp_eq_u32 s60, 0
    s_cbranch_scc1 L_dw_4
    s_waitcnt vmcnt(1)
L_dw_4:
    global_load_dwordx4 v[96:99], v4, s[6:7] offset:2048 nt
    s_waitcnt vmcnt(2)
    s_cmp_eq_u32 s60, 0
    s_cbranch_scc1 L_dw_5
    s_waitcnt vmcnt(1)
L_dw_5:
    global_load_dwordx4 v[100:103], v4, s[6:7] offset:3072 nt
    s_waitcnt vmcnt(2)
    s_cmp_eq_u32 s60, 0
    s_cbranch_scc1 L_dw_6
    s_waitcnt vmcnt(1)
L_dw_6:
    global_load_dwordx4 v[120:123], v3, s[8:9] offset:0 nt
    s_waitcnt vmcnt(2)
    s_cmp_eq_u32 s60, 0
    s_cbranch_scc1 L_dw_7
    s_waitcnt vmcnt(1)
L_dw_7:
    global_load_dwordx4 v[124:127], v3, s[8:9] offset:1024 nt
    s_waitcnt vmcnt(2)
    ds_read_b32 v43, v39 offset:3136
    ds_read_b128 v[60:63], v36 offset:2560
    s_mov_b32 s62, 10
    s_waitcnt lgkmcnt(0)
    v_cmp_eq_u32 vcc, 1, v43
    s_cmp_eq_u64 vcc, -1
    s_cbranch_scc1 L_qk_wo
    s_waitcnt vmcnt(2)
    s_cmp_eq_u32 s60, 0
    s_cbranch_scc1 L_dw_8
    s_waitcnt vmcnt(1)
L_dw_8:
    global_load_dwordx4 v[128:131], v3, s[8:9] offset:2048 nt
    ds_read_b32 v43, v39 offset:3136
    ds_read_b128 v[60:63], v36 offset:2560
    s_mov_b32 s62, 11
    s_waitcnt lgkmcnt(0)
    v_cmp_eq_u32 vcc, 1, v43
    s_cmp_eq_u64 vcc, -1
    s_cbranch_scc1 L_qk_wo
    s_waitcnt vmcnt(2)
    s_cmp_eq_u32 s60, 0
    s_cbranch_scc1 L_dw_9
    s_waitcnt vmcnt(1)
L_dw_9:
    global_load_dwordx4 v[132:135], v3, s[8:9] offset:3072 nt
    ds_read_b32 v43, v39 offset:3136
    ds_read_b128 v[60:63], v36 offset:2560
    s_mov_b32 s62, 12
    s_waitcnt lgkmcnt(0)
    v_cmp_eq_u32 vcc, 1, v43
    s_cmp_eq_u64 vcc, -1
    s_cbranch_scc1 L_qk_wo
    s_waitcnt vmcnt(2)
    s_cmp_eq_u32 s60, 0
    s_cbranch_scc1 L_dw_10
    s_waitcnt vmcnt(1)
L_dw_10:
    global_load_dwordx4 v[136:139], v4, s[8:9] offset:0 nt
    ds_read_b32 v43, v39 offset:3136
    ds_read_b128 v[60:63], v36 offset:2560
    s_mov_b32 s62, 13
    s_waitcnt lgkmcnt(0)
    v_cmp_eq_u32 vcc, 1, v43
    s_cmp_eq_u64 vcc, -1
    s_cbranch_scc1 L_qk_wo
    s_waitcnt vmcnt(2)
    s_cmp_eq_u32 s60, 0
    s_cbranch_scc1 L_dw_11
    s_waitcnt vmcnt(1)
L_dw_11:
    global_load_dwordx4 v[140:143], v4, s[8:9] offset:1024 nt
    ds_read_b32 v43, v39 offset:3136
    ds_read_b128 v[60:63], v36 offset:2560
    s_mov_b32 s62, 14
    s_waitcnt lgkmcnt(0)
    v_cmp_eq_u32 vcc, 1, v43
    s_cmp_eq_u64 vcc, -1
    s_cbranch_scc1 L_qk_wo
    s_waitcnt vmcnt(2)
    s_cmp_eq_u32 s60, 0
    s_cbranch_scc1 L_dw_12
    s_waitcnt vmcnt(1)
L_dw_12:
    global_load_dwordx4 v[144:147], v4, s[8:9] offset:2048 nt
    ds_read_b32 v43, v39 offset:3136
    ds_read_b128 v[60:63], v36 offset:2560
    s_mov_b32 s62, 15
    s_waitcnt lgkmcnt(0)
    v_cmp_eq_u32 vcc, 1, v43
    s_cmp_eq_u64 vcc, -1
    s_cbranch_scc1 L_qk_wo
    s_waitcnt vmcnt(2)
    s_cmp_eq_u32 s60, 0
    s_cbranch_scc1 L_dw_13
    s_waitcnt vmcnt(1)
L_dw_13:
    global_load_dwordx4 v[148:151], v4, s[8:9] offset:3072 nt
    ds_read_b32 v43, v39 offset:3136
    ds_read_b128 v[60:63], v36 offset:2560
    s_mov_b32 s62, 16
    s_waitcnt lgkmcnt(0)
    v_cmp_eq_u32 vcc, 1, v43
    s_cmp_eq_u64 vcc, -1
    s_cbranch_scc1 L_qk_wo
L_qs_wo:
    s_add_u32 s59, s59, 1
    s_cmp_gt_u32 s59, 1048576
    s_cbranch_scc1 L_end
    ds_read_b32 v43, v39 offset:3136
    ds_read_b128 v[60:63], v36 offset:2560
    s_waitcnt lgkmcnt(0)
    v_cmp_eq_u32 vcc, 1, v43
    s_cmp_eq_u64 vcc, -1
    s_cbranch_scc0 L_qs_wo
L_qk_wo:
    v_dot2_f32_bf16 v16, v72, v60, 0
    v_dot2_f32_bf16 v17, v76, v60, 0
    v_dot2_f32_bf16 v18, v80, v60, 0
    v_dot2_f32_bf16 v19, v84, v60, 0
    v_dot2_f32_bf16 v20, v88, v60, 0
    v_dot2_f32_bf16 v21, v92, v60, 0
    v_dot2_f32_bf16 v22, v96, v60, 0
    v_dot2_f32_bf16 v23, v100, v60, 0
    v_dot2c_f32_bf16 v16, v73, v61
    v_dot2c_f32_bf16 v17, v77, v61
    v_dot2c_f32_bf16 v18, v81, v61
    v_dot2c_f32_bf16 v19, v85, v61
    v_dot2c_f32_bf16 v20, v89, v61
    v_dot2c_f32_bf16 v21, v93, v61
    v_dot2c_f32_bf16 v22, v97, v61
    v_dot2c_f32_bf16 v23, v101, v61
    v_dot2c_f32_bf16 v16, v74, v62
    v_dot2c_f32_bf16 v17, v78, v62
    v_dot2c_f32_bf16 v18, v82, v62
    v_dot2c_f32_bf16 v19, v86, v62
    v_dot2c_f32_bf16 v20, v90, v62
    v_dot2c_f32_bf16 v21, v94, v62
    v_dot2c_f32_bf16 v22, v98, v62
    v_dot2c_f32_bf16 v23, v102, v62
    v_dot2c_f32_bf16 v16, v75, v63
    v_dot2c_f32_bf16 v17, v79, v63
    v_dot2c_f32_bf16 v18, v83, v63
    v_dot2c_f32_bf16 v19, v87, v63
    v_dot2c_f32_bf16 v20, v91, v63
    v_dot2c_f32_bf16 v21, v95, v63
    v_dot2c_f32_bf16 v22, v99, v63
    v_dot2c_f32_bf16 v23, v103, v63
    s_mov_b32 s34, 1035273459
    s_mov_b32 s35, 1069066811
    v_add_f32_dpp v16, v16, v16 row_ror:8 row_mask:0xf bank_mask:0xf
    v_add_f32_dpp v17, v17, v17 row_ror:8 row_mask:0xf bank_mask:0xf
    v_add_f32_dpp v18, v18, v18 row_ror:8 row_mask:0xf bank_mask:0xf
    v_add_f32_dpp v19, v19, v19 row_ror:8 row_mask:0xf bank_mask:0xf
    v_add_f32_dpp v20, v20, v20 row_ror:8 row_mask:0xf bank_mask:0xf
    v_add_f32_dpp v21, v21, v21 row_ror:8 row_mask:0xf bank_mask:0xf
    v_add_f32_dpp v22, v22, v22 row_ror:8 row_mask:0xf bank_mask:0xf
    v_add_f32_dpp v23, v23, v23 row_ror:8 row_mask:0xf bank_mask:0xf
    v_add_f32_dpp v16, v16, v16 row_ror:4 row_mask:0xf bank_mask:0xf
    v_add_f32_dpp v17, v17, v17 row_ror:4 row_mask:0xf bank_mask:0xf
    v_add_f32_dpp v18, v18, v18 row_ror:4 row_mask:0xf bank_mask:0xf
    v_add_f32_dpp v19, v19, v19 row_ror:4 row_mask:0xf bank_mask:0xf
    v_add_f32_dpp v20, v20, v20 row_ror:4 row_mask:0xf bank_mask:0xf
    v_add_f32_dpp v21, v21, v21 row_ror:4 row_mask:0xf bank_mask:0xf
    v_add_f32_dpp v22, v22, v22 row_ror:4 row_mask:0xf bank_mask:0xf
    v_add_f32_dpp v23, v23, v23 row_ror:4 row_mask:0xf bank_mask:0xf
    v_add_f32_dpp v16, v16, v16 row_ror:2 row_mask:0xf bank_mask:0xf
    v_add_f32_dpp v17, v17, v17 row_ror:2 row_mask:0xf bank_mask:0xf
    v_add_f32_dpp v18, v18, v18 row_ror:2 row_mask:0xf bank_mask:0xf
    v_add_f32_dpp v19, v19, v19 row_ror:2 row_mask:0xf bank_mask:0xf
    v_add_f32_dpp v20, v20, v20 row_ror:2 row_mask:0xf bank_mask:0xf
    v_add_f32_dpp v21, v21, v21 row_ror:2 row_mask:0xf bank_mask:0xf
    v_add_f32_dpp v22, v22, v22 row_ror:2 row_mask:0xf bank_mask:0xf
    v_add_f32_dpp v23, v23, v23 row_ror:2 row_mask:0xf bank_mask:0xf
    v_add_f32_dpp v16, v16, v16 row_ror:1 row_mask:0xf bank_mask:0xf
    v_add_f32_dpp v17, v17, v17 row_ror:1 row_mask:0xf bank_mask:0xf
    v_add_f32_dpp v18, v18, v18 row_ror:1 row_mask:0xf bank_mask:0xf
    v_add_f32_dpp v19, v19, v19 row_ror:1 row_mask:0xf bank_mask:0xf
    v_add_f32_dpp v20, v20, v20 row_ror:1 row_mask:0xf bank_mask:0xf
    v_add_f32_dpp v21, v21, v21 row_ror:1 row_mask:0xf bank_mask:0xf
    v_add_f32_dpp v22, v22, v22 row_ror:1 row_mask:0xf bank_mask:0xf
    v_add_f32_dpp v23, v23, v23 row_ror:1 row_mask:0xf bank_mask:0xf
    v_cvt_pk_bf16_f32 v48, v16, v17
    v_cvt_pk_bf16_f32 v50, v18, v19
    v_cvt_pk_bf16_f32 v52, v20, v21
    v_cvt_pk_bf16_f32 v54, v22, v23
    v_lshlrev_b32 v16, 16, v48
    v_and_b32 v17, 0xffff0000, v48
    v_lshlrev_b32 v18, 16, v50
    v_and_b32 v19, 0xffff0000, v50
    v_lshlrev_b32 v20, 16, v52
    v_and_b32 v21, 0xffff0000, v52
    v_lshlrev_b32 v22, 16, v54
    v_and_b32 v23, 0xffff0000, v54
    v_mul_f32 v16, s34, v16
    v_mul_f32 v17, s34, v17
    v_mul_f32 v18, s34, v18
    v_mul_f32 v19, s34, v19
    v_mul_f32 v20, s34, v20
    v_mul_f32 v21, s34, v21
    v_mul_f32 v22, s34, v22
    v_mul_f32 v23, s34, v23
    v_cvt_pk_bf16_f32 v48, v16, v17
    v_cvt_pk_bf16_f32 v50, v18, v19
    v_cvt_pk_bf16_f32 v52, v20, v21
    v_cvt_pk_bf16_f32 v54, v22, v23
    v_lshlrev_b32 v16, 16, v48
    v_and_b32 v17, 0xffff0000, v48
    v_lshlrev_b32 v18, 16, v50
    v_and_b32 v19, 0xffff0000, v50
    v_lshlrev_b32 v20, 16, v52
    v_and_b32 v21, 0xffff0000, v52
    v_lshlrev_b32 v22, 16, v54
    v_and_b32 v23, 0xffff0000, v54
    v_max3_f32 v28, v16, v17, v18
    v_max3_f32 v27, v19, v20, v21
    v_max3_f32 v28, v28, v22, v23
    v_max_f32 v28, v28, v27
    v_mov_b32 v27, v28
    s_nop 1
    v_permlane16_swap_b32 v28, v27
    v_max_f32 v28, v28, v27
    v_mov_b32 v27, v28
    s_nop 1
    v_permlane32_swap_b32 v28, v27
    v_max_f32 v28, v28, v27
    v_mul_f32 v28, s35, v28
    v_fma_f32 v16, v16, s35, -v28
    v_fma_f32 v17, v17, s35, -v28
    v_fma_f32 v18, v18, s35, -v28
    v_fma_f32 v19, v19, s35, -v28
    v_fma_f32 v20, v20, s35, -v28
    v_fma_f32 v21, v21, s35, -v28
    v_fma_f32 v22, v22, s35, -v28
    v_fma_f32 v23, v23, s35, -v28
    v_exp_f32 v16, v16
    v_exp_f32 v17, v17
    v_exp_f32 v18, v18
    v_exp_f32 v19, v19
    v_exp_f32 v20, v20
    v_exp_f32 v21, v21
    v_exp_f32 v22, v22
    v_exp_f32 v23, v23
    v_cvt_pk_bf16_f32 v48, v16, v16
    v_cvt_pk_bf16_f32 v49, v17, v17
    v_cvt_pk_bf16_f32 v50, v18, v18
    v_cvt_pk_bf16_f32 v51, v19, v19
    v_cvt_pk_bf16_f32 v52, v20, v20
    v_cvt_pk_bf16_f32 v53, v21, v21
    v_cvt_pk_bf16_f32 v54, v22, v22
    v_cvt_pk_bf16_f32 v55, v23, v23
    v_add_f32 v16, v16, v17
    v_add_f32 v18, v18, v19
    v_add_f32 v20, v20, v21
    v_add_f32 v22, v22, v23
    v_add_f32 v16, v16, v18
    v_add_f32 v20, v20, v22
    v_add_f32 v29, v16, v20
    v_mov_b32 v27, v29
    s_nop 1
    v_permlane16_swap_b32 v29, v27
    v_add_f32 v29, v29, v27
    v_mov_b32 v27, v29
    s_nop 1
    v_permlane32_swap_b32 v29, v27
    v_add_f32 v29, v29, v27
    v_mov_b32 v30, 1
    ds_write_b128 v41, v[28:31] offset:3200
    s_cmp_gt_u32 s62, 10
    s_cbranch_scc1 L_sk_14
    s_waitcnt vmcnt(4)
    s_cmp_eq_u32 s60, 0
    s_cbranch_scc1 L_dw_15
    s_waitcnt vmcnt(3)
L_dw_15:
    global_load_dwordx4 v[128:131], v3, s[8:9] offset:2048 nt
L_sk_14:
    v_and_b32 v72, v48, v32
    v_and_b32 v73, v48, v33
    v_and_b32 v74, v48, v34
    v_and_b32 v75, v48, v35
    v_and_b32 v76, v49, v32
    v_and_b32 v77, v49, v33
    v_and_b32 v78, v49, v34
    v_and_b32 v79, v49, v35
    s_cmp_gt_u32 s62, 11
    s_cbranch_scc1 L_sk_16
    s_waitcnt vmcnt(4)
    s_cmp_eq_u32 s60, 0
    s_cbranch_scc1 L_dw_17
    s_waitcnt vmcnt(3)
L_dw_17:
    global_load_dwordx4 v[132:135], v3, s[8:9] offset:3072 nt
L_sk_16:
    v_and_b32 v80, v50, v32
    v_and_b32 v81, v50, v33
    v_and_b32 v82, v50, v34
    v_and_b32 v83, v50, v35
    v_and_b32 v84, v51, v32
    v_and_b32 v85, v51, v33
    v_and_b32 v86, v51, v34
    v_and_b32 v87, v51, v35
    s_cmp_gt_u32 s62, 12
    s_cbranch_scc1 L_sk_18
    s_waitcnt vmcnt(4)
    s_cmp_eq_u32 s60, 0
    s_cbranch_scc1 L_dw_19
    s_waitcnt vmcnt(3)
L_dw_19:
    global_load_dwordx4 v[136:139], v4, s[8:9] offset:0 nt
L_sk_18:
    v_and_b32 v88, v52, v32
    v_and_b32 v89, v52, v33
    v_and_b32 v90, v52, v34
    v_and_b32 v91, v52, v35
    v_and_b32 v92, v53, v32
    v_and_b32 v93, v53, v33
    v_and_b32 v94, v53, v34
    v_and_b32 v95, v53, v35
    s_cmp_gt_u32 s62, 13
    s_cbranch_scc1 L_sk_20
    s_waitcnt vmcnt(4)
    s_cmp_eq_u32 s60, 0
    s_cbranch_scc1 L_dw_21
    s_waitcnt vmcnt(3)
L_dw_21:
    global_load_dwordx4 v[140:143], v4, s[8:9] offset:1024 nt
L_sk_20:
    v_and_b32 v96, v54, v32
    v_and_b32 v97, v54, v33
    v_and_b32 v98, v54, v34
    v_and_b32 v99, v54, v35
    v_and_b32 v100, v55, v32
    v_and_b32 v101, v55, v33
    v_and_b32 v102, v55, v34
    v_and_b32 v103, v55, v35
    s_cmp_gt_u32 s62, 14
    s_cbranch_scc1 L_sk_22
    s_waitcnt vmcnt(4)
    s_cmp_eq_u32 s60, 0
    s_cbranch_scc1 L_dw_23
    s_waitcnt vmcnt(3)
L_dw_23:
    global_load_dwordx4 v[144:147], v4, s[8:9] offset:2048 nt
L_sk_22:
    s_cmp_gt_u32 s62, 15
    s_cbranch_scc1 L_sk_24
    s_waitcnt vmcnt(4)
    s_cmp_eq_u32 s60, 0
    s_cbranch_scc1 L_dw_25
    s_waitcnt vmcnt(3)
L_dw_25:
    global_load_dwordx4 v[148:151], v4, s[8:9] offset:3072 nt
L_sk_24:
    s_load_dwordx4 s[16:19], s[56:57], 0 glc
    s_load_dwordx4 s[20:23], s[56:57], 128 glc
    s_load_dwordx4 s[48:51], s[56:57], 256 glc
    s_load_dwordx4 s[52:55], s[56:57], 384 glc
    s_waitcnt vmcnt(7)
    v_mfma_f32_16x16x32_bf16 v[44:47], v[72:75], v[120:123], 0
    s_waitcnt vmcnt(6)
    v_mfma_f32_16x16x32_bf16 v[44:47], v[76:79], v[124:127], v[44:47]
    s_waitcnt vmcnt(5)
    v_mfma_f32_16x16x32_bf16 v[44:47], v[80:83], v[128:131], v[44:47]
    s_waitcnt vmcnt(4)
    v_mfma_f32_16x16x32_bf16 v[44:47], v[84:87], v[132:135], v[44:47]
    s_waitcnt vmcnt(3)
    s_mov_b32 m0, s38
    s_add_u32 s38, s38, 8192
    global_load_lds_dwordx4 v40, s[12:13] nt
    s_add_u32 s12, s12, 1310720
    s_addc_u32 s13, s13, 0
    v_mfma_f32_16x16x32_bf16 v[44:47], v[88:91], v[136:139], v[44:47]
    s_waitcnt vmcnt(3)
    s_mov_b32 m0, s38
    s_add_u32 s38, s38, 8192
    global_load_lds_dwordx4 v40, s[12:13] nt
    s_add_u32 s12, s12, 1310720
    s_addc_u32 s13, s13, 0
    v_mfma_f32_16x16x32_bf16 v[44:47], v[92:95], v[140:143], v[44:47]
    s_waitcnt vmcnt(3)
    s_mov_b32 m0, s38
    s_add_u32 s38, s38, 8192
    global_load_lds_dwordx4 v40, s[12:13] nt
    s_add_u32 s12, s12, 1310720
    s_addc_u32 s13, s13, 0
    v_mfma_f32_16x16x32_bf16 v[44:47], v[96:99], v[144:147], v[44:47]
    s_waitcnt vmcnt(3)
    s_mov_b32 m0, s38
    s_add_u32 s38, s38, 8192
    global_load_lds_dwordx4 v40, s[12:13] nt
    s_add_u32 s12, s12, 1310720
    s_addc_u32 s13, s13, 0
    v_mfma_f32_16x16x32_bf16 v[44:47], v[100:103], v[148:151], v[44:47]
    s_mov_b64 exec, 0xffffffff
    s_nop 7
    ds_write_b128 v37, v[44:47] offset:4096
    ds_write_b32 v38, v42 offset:3328
    s_mov_b64 exec, -1
    s_getreg_b32 s34, hwreg(HW_REG_XCC_ID)
    s_branch L_stc
L_stp:
    s_add_u32 s59, s59, 1
    s_cmp_gt_u32 s59, 1048576
    s_cbranch_scc1 L_end
L_stp0:
    s_load_dwordx4 s[16:19], s[56:57], 0 glc
    s_load_dwordx4 s[20:23], s[56:57], 128 glc
    s_load_dwordx4 s[48:51], s[56:57], 256 glc
    s_load_dwordx4 s[52:55], s[56:57], 384 glc
L_stc:
    s_waitcnt lgkmcnt(0)
    s_cmp_lg_u32 s19, s28
    s_cbranch_scc1 L_stp
    s_cmp_lg_u32 s23, s28
    s_cbranch_scc1 L_stp
    s_cmp_lg_u32 s51, s28
    s_cbranch_scc1 L_stp
    s_cmp_lg_u32 s55, s28
    s_cbranch_scc1 L_stp
    s_cmp_eq_u32 s18, s34
    s_cselect_b32 s18, 131072, 0
    s_cmp_eq_u32 s22, s34
    s_cselect_b32 s22, 131072, 0
    s_cmp_eq_u32 s50, s34
    s_cselect_b32 s50, 131072, 0
    s_cmp_eq_u32 s54, s34
    s_cselect_b32 s54, 131072, 0
    s_mov_b64 exec, 0xffffffff
    v_mov_b32 v20, s16
    v_mov_b32 v22, s48
    v_mov_b32 v16, s17
    v_mov_b32 v17, s49
    v_add_u32 v26, s18, v8
    v_add_u32 v27, s50, v8
    s_not_b64 exec, exec
    v_mov_b32 v20, s20
    v_mov_b32 v22, s52
    v_mov_b32 v16, s21
    v_mov_b32 v17, s53
    v_add_u32 v26, s22, v8
    v_add_u32 v27, s54, v8
    s_mov_b64 exec, -1
    v_max_f32 v18, v20, v22
    v_mov_b32 v19, v18
    s_nop 1
    v_permlane32_swap_b32 v18, v19
    v_max_f32 v18, v18, v19
    v_sub_f32 v20, v20, v18
    v_sub_f32 v22, v22, v18
    v_exp_f32 v20, v20
    v_exp_f32 v22, v22
    v_mul_f32 v16, v16, v20
    v_fmac_f32 v16, v17, v22
    v_mov_b32 v19, v16
    s_nop 1
    v_permlane32_swap_b32 v16, v19
    v_add_f32 v16, v16, v19
    v_rcp_f32 v16, v16
    s_nop 0
    v_mul_f32 v20, v20, v16
    v_mul_f32 v22, v22, v16
    v_and_b32 v43, 7, v1
    v_lshlrev_b32 v40, 2, v43
L_ow:
    s_add_u32 s59, s59, 1
    s_cmp_gt_u32 s59, 1048576
    s_cbranch_scc1 L_end
    ds_read_b32 v43, v40 offset:3328
    s_waitcnt lgkmcnt(0)
    v_cmp_eq_u32 vcc, 1, v43
    s_cmp_eq_u64 vcc, -1
    s_cbranch_scc0 L_ow
    s_mov_b32 s48, -1
    s_mov_b32 s49, -1
    s_mov_b32 s50, -1
    s_mov_b32 s51, -1
L_opoll:
    s_add_u32 s59, s59, 1
    s_cmp_gt_u32 s59, 1048576
    s_cbranch_scc1 L_end
    s_mov_b64 exec, s[48:49]
    global_load_dwordx4 v[72:75], v26, s[26:27] sc1
    s_mov_b64 exec, s[50:51]
    global_load_dwordx4 v[76:79], v27, s[26:27] offset:1024 sc1
    s_mov_b64 exec, s[48:49]
    s_waitcnt vmcnt(1)
    v_xor_b32 v72, s44, v72
    v_xor_b32 v73, s45, v73
    v_xor_b32 v74, s46, v74
    v_xor_b32 v75, s47, v75
    v_or3_b32 v24, v72, v73, v74
    v_or_b32 v24, v24, v75
    v_cmp_ne_u32_sdwa s[48:49], v24, 0 src0_sel:BYTE_0 src1_sel:DWORD
    s_mov_b64 exec, s[50:51]
    s_waitcnt vmcnt(0)
    v_xor_b32 v76, s44, v76
    v_xor_b32 v77, s45, v77
    v_xor_b32 v78, s46, v78
    v_xor_b32 v79, s47, v79
    v_or3_b32 v24, v76, v77, v78
    v_or_b32 v24, v24, v79
    v_cmp_ne_u32_sdwa s[50:51], v24, 0 src0_sel:BYTE_0 src1_sel:DWORD
    s_mov_b64 exec, -1
    ds_write_b32 v38, v42 offset:3360
    s_wqm_b64 s[48:49], s[48:49]
    s_wqm_b64 s[50:51], s[50:51]
    s_or_b64 vcc, s[48:49], s[50:51]
    s_cbranch_scc1 L_opoll
    v_pk_mul_f32 v[80:81], v[72:73], v[20:21] op_sel_hi:[1,0]
    v_pk_mul_f32 v[82:83], v[74:75], v[20:21] op_sel_hi:[1,0]
    v_pk_fma_f32 v[80:81], v[76:77], v[22:23], v[80:81] op_sel_hi:[1,0,1]
    v_pk_fma_f32 v[82:83], v[78:79], v[22:23], v[82:83] op_sel_hi:[1,0,1]
    s_nop 0
    v_permlane32_swap_b32 v80, v81
    v_permlane32_swap_b32 v82, v83
    v_add_f32 v80, v80, v81
    v_add_f32 v82, v82, v83
    v_cvt_pk_bf16_f32 v80, v80, v82
    ds_write_b16 v10, v80 offset:8192
    ds_write_b16_d16_hi v10, v80 offset:8704
    s_waitcnt lgkmcnt(0)
    s_barrier
    s_endpgm
L_att_plain:
    s_waitcnt vmcnt(3)
    s_cmp_eq_u32 s60, 0
    s_cbranch_scc1 L_dw_26
    s_waitcnt vmcnt(2)
L_dw_26:
    global_load_dwordx4 v[84:87], v3, s[6:7] offset:3072 nt
    s_waitcnt vmcnt(3)
    s_cmp_eq_u32 s60, 0
    s_cbranch_scc1 L_dw_27
    s_waitcnt vmcnt(2)
L_dw_27:
    global_load_dwordx4 v[88:91], v4, s[6:7] offset:0 nt
    s_waitcnt vmcnt(3)
    s_cmp_eq_u32 s60, 0
    s_cbranch_scc1 L_dw_28
    s_waitcnt vmcnt(2)
L_dw_28:
    global_load_dwordx4 v[92:95], v4, s[6:7] offset:1024 nt
    s_waitcnt vmcnt(3)
    s_cmp_eq_u32 s60, 0
    s_cbranch_scc1 L_dw_29
    s_waitcnt vmcnt(2)
L_dw_29:
    global_load_dwordx4 v[96:99], v4, s[6:7] offset:2048 nt
    s_waitcnt vmcnt(3)
    s_cmp_eq_u32 s60, 0
    s_cbranch_scc1 L_dw_30
    s_waitcnt vmcnt(2)
L_dw_30:
    global_load_dwordx4 v[100:103], v4, s[6:7] offset:3072 nt
    s_waitcnt vmcnt(3)
    s_cmp_eq_u32 s60, 0
    s_cbranch_scc1 L_dw_31
    s_waitcnt vmcnt(2)
L_dw_31:
    global_load_dwordx4 v[104:107], v5, s[6:7] offset:0 nt
    s_waitcnt vmcnt(3)
    s_cmp_eq_u32 s60, 0
    s_cbranch_scc1 L_dw_32
    s_waitcnt vmcnt(2)
L_dw_32:
    global_load_dwordx4 v[108:111], v5, s[6:7] offset:1024 nt
    s_waitcnt vmcnt(3)
    s_cmp_eq_u32 s60, 0
    s_cbranch_scc1 L_dw_33
    s_waitcnt vmcnt(2)
L_dw_33:
    global_load_dwordx4 v[112:115], v5, s[6:7] offset:2048 nt
    s_waitcnt vmcnt(3)
    s_cmp_eq_u32 s60, 0
    s_cbranch_scc1 L_dw_34
    s_waitcnt vmcnt(2)
L_dw_34:
    global_load_dwordx4 v[116:119], v5, s[6:7] offset:3072 nt
    s_waitcnt vmcnt(3)
    s_cmp_eq_u32 s60, 0
    s_cbranch_scc1 L_dw_35
    s_waitcnt vmcnt(2)
L_dw_35:
    global_load_dwordx4 v[120:123], v3, s[8:9] offset:0 nt
    s_waitcnt vmcnt(3)
    s_cmp_eq_u32 s60, 0
    s_cbranch_scc1 L_dw_36
    s_waitcnt vmcnt(2)
L_dw_36:
    global_load_dwordx4 v[124:127], v3, s[8:9] offset:1024 nt
    s_waitcnt vmcnt(3)
    s_cmp_eq_u32 s60, 0
    s_cbranch_scc1 L_dw_37
    s_waitcnt vmcnt(2)
L_dw_37:
    global_load_dwordx4 v[128:131], v3, s[8:9] offset:2048 nt
    s_waitcnt vmcnt(3)
    ds_read_b32 v43, v39 offset:3136
    ds_read_b128 v[60:63], v36 offset:2560
    s_mov_b32 s62, 15
    s_waitcnt lgkmcnt(0)
    v_cmp_eq_u32 vcc, 1, v43
    s_cmp_eq_u64 vcc, -1
    s_cbranch_scc1 L_qk_plain
    s_waitcnt vmcnt(3)
    s_cmp_eq_u32 s60, 0
    s_cbranch_scc1 L_dw_38
    s_waitcnt vmcnt(2)
L_dw_38:
    global_load_dwordx4 v[132:135], v3, s[8:9] offset:3072 nt
    ds_read_b32 v43, v39 offset:3136
    ds_read_b128 v[60:63], v36 offset:2560
    s_mov_b32 s62, 16
    s_waitcnt lgkmcnt(0)
    v_cmp_eq_u32 vcc, 1, v43
    s_cmp_eq_u64 vcc, -1
    s_cbranch_scc1 L_qk_plain
    s_waitcnt vmcnt(3)
    s_cmp_eq_u32 s60, 0
    s_cbranch_scc1 L_dw_39
    s_waitcnt vmcnt(2)
L_dw_39:
    global_load_dwordx4 v[136:139], v4, s[8:9] offset:0 nt
    ds_read_b32 v43, v39 offset:3136
    ds_read_b128 v[60:63], v36 offset:2560
    s_mov_b32 s62, 17
    s_waitcnt lgkmcnt(0)
    v_cmp_eq_u32 vcc, 1, v43
    s_cmp_eq_u64 vcc, -1
    s_cbranch_scc1 L_qk_plain
    s_waitcnt vmcnt(3)
    s_cmp_eq_u32 s60, 0
    s_cbranch_scc1 L_dw_40
    s_waitcnt vmcnt(2)
L_dw_40:
    global_load_dwordx4 v[140:143], v4, s[8:9] offset:1024 nt
    ds_read_b32 v43, v39 offset:3136
    ds_read_b128 v[60:63], v36 offset:2560
    s_mov_b32 s62, 18
    s_waitcnt lgkmcnt(0)
    v_cmp_eq_u32 vcc, 1, v43
    s_cmp_eq_u64 vcc, -1
    s_cbranch_scc1 L_qk_plain
    s_waitcnt vmcnt(3)
    s_cmp_eq_u32 s60, 0
    s_cbranch_scc1 L_dw_41
    s_waitcnt vmcnt(2)
L_dw_41:
    global_load_dwordx4 v[144:147], v4, s[8:9] offset:2048 nt
    ds_read_b32 v43, v39 offset:3136
    ds_read_b128 v[60:63], v36 offset:2560
    s_mov_b32 s62, 19
    s_waitcnt lgkmcnt(0)
    v_cmp_eq_u32 vcc, 1, v43
    s_cmp_eq_u64 vcc, -1
    s_cbranch_scc1 L_qk_plain
    s_waitcnt vmcnt(3)
    s_cmp_eq_u32 s60, 0
    s_cbranch_scc1 L_dw_42
    s_waitcnt vmcnt(2)
L_dw_42:
    global_load_dwordx4 v[148:151], v4, s[8:9] offset:3072 nt
    ds_read_b32 v43, v39 offset:3136
    ds_read_b128 v[60:63], v36 offset:2560
    s_mov_b32 s62, 20
    s_waitcnt lgkmcnt(0)
    v_cmp_eq_u32 vcc, 1, v43
    s_cmp_eq_u64 vcc, -1
    s_cbranch_scc1 L_qk_plain
    s_waitcnt vmcnt(3)
    s_cmp_eq_u32 s60, 0
    s_cbranch_scc1 L_dw_43
    s_waitcnt vmcnt(2)
L_dw_43:
    global_load_dwordx4 v[152:155], v5, s[8:9] offset:0 nt
    ds_read_b32 v43, v39 offset:3136
    ds_read_b128 v[60:63], v36 offset:2560
    s_mov_b32 s62, 21
    s_waitcnt lgkmcnt(0)
    v_cmp_eq_u32 vcc, 1, v43
    s_cmp_eq_u64 vcc, -1
    s_cbranch_scc1 L_qk_plain
    s_waitcnt vmcnt(3)
    s_cmp_eq_u32 s60, 0
    s_cbranch_scc1 L_dw_44
    s_waitcnt vmcnt(2)
L_dw_44:
    global_load_dwordx4 v[156:159], v5, s[8:9] offset:1024 nt
    ds_read_b32 v43, v39 offset:3136
    ds_read_b128 v[60:63], v36 offset:2560
    s_mov_b32 s62, 22
    s_waitcnt lgkmcnt(0)
    v_cmp_eq_u32 vcc, 1, v43
    s_cmp_eq_u64 vcc, -1
    s_cbranch_scc1 L_qk_plain
    s_waitcnt vmcnt(3)
    s_cmp_eq_u32 s60, 0
    s_cbranch_scc1 L_dw_45
    s_waitcnt vmcnt(2)
L_dw_45:
    global_load_dwordx4 v[160:163], v5, s[8:9] offset:2048 nt
    ds_read_b32 v43, v39 offset:3136
    ds_read_b128 v[60:63], v36 offset:2560
    s_mov_b32 s62, 23
    s_waitcnt lgkmcnt(0)
    v_cmp_eq_u32 vcc, 1, v43
    s_cmp_eq_u64 vcc, -1
    s_cbranch_scc1 L_qk_plain
    s_waitcnt vmcnt(3)
    s_cmp_eq_u32 s60, 0
    s_cbranch_scc1 L_dw_46
    s_waitcnt vmcnt(2)
L_dw_46:
    global_load_dwordx4 v[164:167], v5, s[8:9] offset:3072 nt
    ds_read_b32 v43, v39 offset:3136
    ds_read_b128 v[60:63], v36 offset:2560
    s_mov_b32 s62, 24
    s_waitcnt lgkmcnt(0)
    v_cmp_eq_u32 vcc, 1, v43
    s_cmp_eq_u64 vcc, -1
    s_cbranch_scc1 L_qk_plain
L_qs_plain:
    s_add_u32 s59, s59, 1
    s_cmp_gt_u32 s59, 1048576
    s_cbranch_scc1 L_end
    ds_read_b32 v43, v39 offset:3136
    ds_read_b128 v[60:63], v36 offset:2560
    s_waitcnt lgkmcnt(0)
    v_cmp_eq_u32 vcc, 1, v43
    s_cmp_eq_u64 vcc, -1
    s_cbranch_scc0 L_qs_plain
L_qk_plain:
    v_dot2_f32_bf16 v8, v72, v60, 0
    v_dot2_f32_bf16 v9, v76, v60, 0
    v_dot2_f32_bf16 v10, v80, v60, 0
    v_dot2_f32_bf16 v11, v84, v60, 0
    v_dot2_f32_bf16 v12, v88, v60, 0
    v_dot2_f32_bf16 v13, v92, v60, 0
    v_dot2_f32_bf16 v14, v96, v60, 0
    v_dot2_f32_bf16 v15, v100, v60, 0
    v_dot2_f32_bf16 v16, v104, v60, 0
    v_dot2_f32_bf16 v17, v108, v60, 0
    v_dot2_f32_bf16 v18, v112, v60, 0
    v_dot2_f32_bf16 v19, v116, v60, 0
    v_dot2c_f32_bf16 v8, v73, v61
    v_dot2c_f32_bf16 v9, v77, v61
    v_dot2c_f32_bf16 v10, v81, v61
    v_dot2c_f32_bf16 v11, v85, v61
    v_dot2c_f32_bf16 v12, v89, v61
    v_dot2c_f32_bf16 v13, v93, v61
    v_dot2c_f32_bf16 v14, v97, v61
    v_dot2c_f32_bf16 v15, v101, v61
    v_dot2c_f32_bf16 v16, v105, v61
    v_dot2c_f32_bf16 v17, v109, v61
    v_dot2c_f32_bf16 v18, v113, v61
    v_dot2c_f32_bf16 v19, v117, v61
    v_dot2c_f32_bf16 v8, v74, v62
    v_dot2c_f32_bf16 v9, v78, v62
    v_dot2c_f32_bf16 v10, v82, v62
    v_dot2c_f32_bf16 v11, v86, v62
    v_dot2c_f32_bf16 v12, v90, v62
    v_dot2c_f32_bf16 v13, v94, v62
    v_dot2c_f32_bf16 v14, v98, v62
    v_dot2c_f32_bf16 v15, v102, v62
    v_dot2c_f32_bf16 v16, v106, v62
    v_dot2c_f32_bf16 v17, v110, v62
    v_dot2c_f32_bf16 v18, v114, v62
    v_dot2c_f32_bf16 v19, v118, v62
    v_dot2c_f32_bf16 v8, v75, v63
    v_dot2c_f32_bf16 v9, v79, v63
    v_dot2c_f32_bf16 v10, v83, v63
    v_dot2c_f32_bf16 v11, v87, v63
    v_dot2c_f32_bf16 v12, v91, v63
    v_dot2c_f32_bf16 v13, v95, v63
    v_dot2c_f32_bf16 v14, v99, v63
    v_dot2c_f32_bf16 v15, v103, v63
    v_dot2c_f32_bf16 v16, v107, v63
    v_dot2c_f32_bf16 v17, v111, v63
    v_dot2c_f32_bf16 v18, v115, v63
    v_dot2c_f32_bf16 v19, v119, v63
    s_mov_b32 s34, 1035273459
    s_mov_b32 s35, 1069066811
    v_add_f32_dpp v8, v8, v8 row_ror:8 row_mask:0xf bank_mask:0xf
    v_add_f32_dpp v9, v9, v9 row_ror:8 row_mask:0xf bank_mask:0xf
    v_add_f32_dpp v10, v10, v10 row_ror:8 row_mask:0xf bank_mask:0xf
    v_add_f32_dpp v11, v11, v11 row_ror:8 row_mask:0xf bank_mask:0xf
    v_add_f32_dpp v12, v12, v12 row_ror:8 row_mask:0xf bank_mask:0xf
    v_add_f32_dpp v13, v13, v13 row_ror:8 row_mask:0xf bank_mask:0xf
    v_add_f32_dpp v14, v14, v14 row_ror:8 row_mask:0xf bank_mask:0xf
    v_add_f32_dpp v15, v15, v15 row_ror:8 row_mask:0xf bank_mask:0xf
    v_add_f32_dpp v16, v16, v16 row_ror:8 row_mask:0xf bank_mask:0xf
    v_add_f32_dpp v17, v17, v17 row_ror:8 row_mask:0xf bank_mask:0xf
    v_add_f32_dpp v18, v18, v18 row_ror:8 row_mask:0xf bank_mask:0xf
    v_add_f32_dpp v19, v19, v19 row_ror:8 row_mask:0xf bank_mask:0xf
    v_add_f32_dpp v8, v8, v8 row_ror:4 row_mask:0xf bank_mask:0xf
    v_add_f32_dpp v9, v9, v9 row_ror:4 row_mask:0xf bank_mask:0xf
    v_add_f32_dpp v10, v10, v10 row_ror:4 row_mask:0xf bank_mask:0xf
    v_add_f32_dpp v11, v11, v11 row_ror:4 row_mask:0xf bank_mask:0xf
    v_add_f32_dpp v12, v12, v12 row_ror:4 row_mask:0xf bank_mask:0xf
    v_add_f32_dpp v13, v13, v13 row_ror:4 row_mask:0xf bank_mask:0xf
    v_add_f32_dpp v14, v14, v14 row_ror:4 row_mask:0xf bank_mask:0xf
    v_add_f32_dpp v15, v15, v15 row_ror:4 row_mask:0xf bank_mask:0xf
    v_add_f32_dpp v16, v16, v16 row_ror:4 row_mask:0xf bank_mask:0xf
    v_add_f32_dpp v17, v17, v17 row_ror:4 row_mask:0xf bank_mask:0xf
    v_add_f32_dpp v18, v18, v18 row_ror:4 row_mask:0xf bank_mask:0xf
    v_add_f32_dpp v19, v19, v19 row_ror:4 row_mask:0xf bank_mask:0xf
    v_add_f32_dpp v8, v8, v8 row_ror:2 row_mask:0xf bank_mask:0xf
    v_add_f32_dpp v9, v9, v9 row_ror:2 row_mask:0xf bank_mask:0xf
    v_add_f32_dpp v10, v10, v10 row_ror:2 row_mask:0xf bank_mask:0xf
    v_add_f32_dpp v11, v11, v11 row_ror:2 row_mask:0xf bank_mask:0xf
    v_add_f32_dpp v12, v12, v12 row_ror:2 row_mask:0xf bank_mask:0xf
    v_add_f32_dpp v13, v13, v13 row_ror:2 row_mask:0xf bank_mask:0xf
    v_add_f32_dpp v14, v14, v14 row_ror:2 row_mask:0xf bank_mask:0xf
    v_add_f32_dpp v15, v15, v15 row_ror:2 row_mask:0xf bank_mask:0xf
    v_add_f32_dpp v16, v16, v16 row_ror:2 row_mask:0xf bank_mask:0xf
    v_add_f32_dpp v17, v17, v17 row_ror:2 row_mask:0xf bank_mask:0xf
    v_add_f32_dpp v18, v18, v18 row_ror:2 row_mask:0xf bank_mask:0xf
    v_add_f32_dpp v19, v19, v19 row_ror:2 row_mask:0xf bank_mask:0xf
    v_add_f32_dpp v8, v8, v8 row_ror:1 row_mask:0xf bank_mask:0xf
    v_add_f32_dpp v9, v9, v9 row_ror:1 row_mask:0xf bank_mask:0xf
    v_add_f32_dpp v10, v10, v10 row_ror:1 row_mask:0xf bank_mask:0xf
    v_add_f32_dpp v11, v11, v11 row_ror:1 row_mask:0xf bank_mask:0xf
    v_add_f32_dpp v12, v12, v12 row_ror:1 row_mask:0xf bank_mask:0xf
    v_add_f32_dpp v13, v13, v13 row_ror:1 row_mask:0xf bank_mask:0xf
    v_add_f32_dpp v14, v14, v14 row_ror:1 row_mask:0xf bank_mask:0xf
    v_add_f32_dpp v15, v15, v15 row_ror:1 row_mask:0xf bank_mask:0xf
    v_add_f32_dpp v16, v16, v16 row_ror:1 row_mask:0xf bank_mask:0xf
    v_add_f32_dpp v17, v17, v17 row_ror:1 row_mask:0xf bank_mask:0xf
    v_add_f32_dpp v18, v18, v18 row_ror:1 row_mask:0xf bank_mask:0xf
    v_add_f32_dpp v19, v19, v19 row_ror:1 row_mask:0xf bank_mask:0xf
    v_cvt_pk_bf16_f32 v48, v8, v9
    v_cvt_pk_bf16_f32 v50, v10, v11
    v_cvt_pk_bf16_f32 v52, v12, v13
    v_cvt_pk_bf16_f32 v54, v14, v15
    v_cvt_pk_bf16_f32 v56, v16, v17
    v_cvt_pk_bf16_f32 v58, v18, v19
    v_lshlrev_b32 v8, 16, v48
    v_and_b32 v9, 0xffff0000, v48
    v_lshlrev_b32 v10, 16, v50
    v_and_b32 v11, 0xffff0000, v50
    v_lshlrev_b32 v12, 16, v52
    v_and_b32 v13, 0xffff0000, v52
    v_lshlrev_b32 v14, 16, v54
    v_and_b32 v15, 0xffff0000, v54
    v_lshlrev_b32 v16, 16, v56
    v_and_b32 v17, 0xffff0000, v56
    v_lshlrev_b32 v18, 16, v58
    v_and_b32 v19, 0xffff0000, v58
    v_mul_f32 v8, s34, v8
    v_mul_f32 v9, s34, v9
    v_mul_f32 v10, s34, v10
    v_mul_f32 v11, s34, v11
    v_mul_f32 v12, s34, v12
    v_mul_f32 v13, s34, v13
    v_mul_f32 v14, s34, v14
    v_mul_f32 v15, s34, v15
    v_mul_f32 v16, s34, v16
    v_mul_f32 v17, s34, v17
    v_mul_f32 v18, s34, v18
    v_mul_f32 v19, s34, v19
    v_cvt_pk_bf16_f32 v48, v8, v9
    v_cvt_pk_bf16_f32 v50, v10, v11
    v_cvt_pk_bf16_f32 v52, v12, v13
    v_cvt_pk_bf16_f32 v54, v14, v15
    v_cvt_pk_bf16_f32 v56, v16, v17
    v_cvt_pk_bf16_f32 v58, v18, v19
    v_lshlrev_b32 v8, 16, v48
    v_and_b32 v9, 0xffff0000, v48
    v_lshlrev_b32 v10, 16, v50
    v_and_b32 v11, 0xffff0000, v50
    v_lshlrev_b32 v12, 16, v52
    v_and_b32 v13, 0xffff0000, v52
    v_lshlrev_b32 v14, 16, v54
    v_and_b32 v15, 0xffff0000, v54
    v_lshlrev_b32 v16, 16, v56
    v_and_b32 v17, 0xffff0000, v56
    v_lshlrev_b32 v18, 16, v58
    v_and_b32 v19, 0xffff0000, v58
    v_max3_f32 v28, v8, v9, v10
    v_max3_f32 v27, v11, v12, v13
    v_max3_f32 v28, v28, v14, v15
    v_max3_f32 v27, v27, v16, v17
    v_max3_f32 v28, v28, v18, v19
    v_max_f32 v28, v28, v27
    v_mov_b32 v27, v28
    s_nop 1
    v_permlane16_swap_b32 v28, v27
    v_max_f32 v28, v28, v27
    v_mov_b32 v27, v28
    s_nop 1
    v_permlane32_swap_b32 v28, v27
    v_max_f32 v28, v28, v27
    v_mul_f32 v28, s35, v28
    v_fma_f32 v8, v8, s35, -v28
    v_fma_f32 v9, v9, s35, -v28
    v_fma_f32 v10, v10, s35, -v28
    v_fma_f32 v11, v11, s35, -v28
    v_fma_f32 v12, v12, s35, -v28
    v_fma_f32 v13, v13, s35, -v28
    v_fma_f32 v14, v14, s35, -v28
    v_fma_f32 v15, v15, s35, -v28
    v_fma_f32 v16, v16, s35, -v28
    v_fma_f32 v17, v17, s35, -v28
    v_fma_f32 v18, v18, s35, -v28
    v_fma_f32 v19, v19, s35, -v28
    v_exp_f32 v8, v8
    v_exp_f32 v9, v9
    v_exp_f32 v10, v10
    v_exp_f32 v11, v11
    v_exp_f32 v12, v12
    v_exp_f32 v13, v13
    v_exp_f32 v14, v14
    v_exp_f32 v15, v15
    v_exp_f32 v16, v16
    v_exp_f32 v17, v17
    v_exp_f32 v18, v18
    v_exp_f32 v19, v19
    v_cvt_pk_bf16_f32 v48, v8, v8
    v_cvt_pk_bf16_f32 v49, v9, v9
    v_cvt_pk_bf16_f32 v50, v10, v10
    v_cvt_pk_bf16_f32 v51, v11, v11
    v_cvt_pk_bf16_f32 v52, v12, v12
    v_cvt_pk_bf16_f32 v53, v13, v13
    v_cvt_pk_bf16_f32 v54, v14, v14
    v_cvt_pk_bf16_f32 v55, v15, v15
    v_cvt_pk_bf16_f32 v56, v16, v16
    v_cvt_pk_bf16_f32 v57, v17, v17
    v_cvt_pk_bf16_f32 v58, v18, v18
    v_cvt_pk_bf16_f32 v59, v19, v19
    v_add_f32 v8, v8, v9
    v_add_f32 v10, v10, v11
    v_add_f32 v12, v12, v13
    v_add_f32 v14, v14, v15
    v_add_f32 v16, v16, v17
    v_add_f32 v18, v18, v19
    v_add_f32 v8, v8, v10
    v_add_f32 v12, v12, v14
    v_add_f32 v16, v16, v18
    v_add_f32 v8, v8, v12
    v_add_f32 v29, v8, v16
    v_mov_b32 v27, v29
    s_nop 1
    v_permlane16_swap_b32 v29, v27
    v_add_f32 v29, v29, v27
    v_mov_b32 v27, v29
    s_nop 1
    v_permlane32_swap_b32 v29, v27
    v_add_f32 v29, v29, v27
    v_mov_b32 v30, 1
    ds_write_b128 v41, v[28:31] offset:3200
    s_cmp_gt_u32 s62, 15
    s_cbranch_scc1 L_sk_47
    s_waitcnt vmcnt(5)
    s_cmp_eq_u32 s60, 0
    s_cbranch_scc1 L_dw_48
    s_waitcnt vmcnt(4)
L_dw_48:
    global_load_dwordx4 v[132:135], v3, s[8:9] offset:3072 nt
L_sk_47:
    v_and_b32 v72, v48, v32
    v_and_b32 v73, v48, v33
    v_and_b32 v74, v48, v34
    v_and_b32 v75, v48, v35
    v_and_b32 v76, v49, v32
    v_and_b32 v77, v49, v33
    v_and_b32 v78, v49, v34
    v_and_b32 v79, v49, v35
    s_cmp_gt_u32 s62, 16
    s_cbranch_scc1 L_sk_49
    s_waitcnt vmcnt(5)
    s_cmp_eq_u32 s60, 0
    s_cbranch_scc1 L_dw_50
    s_waitcnt vmcnt(4)
L_dw_50:
    global_load_dwordx4 v[136:139], v4, s[8:9] offset:0 nt
L_sk_49:
    v_and_b32 v80, v50, v32
    v_and_b32 v81, v50, v33
    v_and_b32 v82, v50, v34
    v_and_b32 v83, v50, v35
    v_and_b32 v84, v51, v32
    v_and_b32 v85, v51, v33
    v_and_b32 v86, v51, v34
    v_and_b32 v87, v51, v35
    s_cmp_gt_u32 s62, 17
    s_cbranch_scc1 L_sk_51
    s_waitcnt vmcnt(5)
    s_cmp_eq_u32 s60, 0
    s_cbranch_scc1 L_dw_52
    s_waitcnt vmcnt(4)
L_dw_52:
    global_load_dwordx4 v[140:143], v4, s[8:9] offset:1024 nt
L_sk_51:
    v_and_b32 v88, v52, v32
    v_and_b32 v89, v52, v33
    v_and_b32 v90, v52, v34
    v_and_b32 v91, v52, v35
    v_and_b32 v92, v53, v32
    v_and_b32 v93, v53, v33
    v_and_b32 v94, v53, v34
    v_and_b32 v95, v53, v35
    s_cmp_gt_u32 s62, 18
    s_cbranch_scc1 L_sk_53
    s_waitcnt vmcnt(5)
    s_cmp_eq_u32 s60, 0
    s_cbranch_scc1 L_dw_54
    s_waitcnt vmcnt(4)
L_dw_54:
    global_load_dwordx4 v[144:147], v4, s[8:9] offset:2048 nt
L_sk_53:
    v_and_b32 v96, v54, v32
    v_and_b32 v97, v54, v33
    v_and_b32 v98, v54, v34
    v_and_b32 v99, v54, v35
    v_and_b32 v100, v55, v32
    v_and_b32 v101, v55, v33
    v_and_b32 v102, v55, v34
    v_and_b32 v103, v55, v35
    s_cmp_gt_u32 s62, 19
    s_cbranch_scc1 L_sk_55
    s_waitcnt vmcnt(5)
    s_cmp_eq_u32 s60, 0
    s_cbranch_scc1 L_dw_56
    s_waitcnt vmcnt(4)
L_dw_56:
    global_load_dwordx4 v[148:151], v4, s[8:9] offset:3072 nt
L_sk_55:
    v_and_b32 v104, v56, v32
    v_and_b32 v105, v56, v33
    v_and_b32 v106, v56, v34
    v_and_b32 v107, v56, v35
    v_and_b32 v108, v57, v32
    v_and_b32 v109, v57, v33
    v_and_b32 v110, v57, v34
    v_and_b32 v111, v57, v35
    s_cmp_gt_u32 s62, 20
    s_cbranch_scc1 L_sk_57
    s_waitcnt vmcnt(5)
    s_cmp_eq_u32 s60, 0
    s_cbranch_scc1 L_dw_58
    s_waitcnt vmcnt(4)
L_dw_58:
    global_load_dwordx4 v[152:155], v5, s[8:9] offset:0 nt
L_sk_57:
    v_and_b32 v112, v58, v32
    v_and_b32 v113, v58, v33
    v_and_b32 v114, v58, v34
    v_and_b32 v115, v58, v35
    v_and_b32 v116, v59, v32
    v_and_b32 v117, v59, v33
    v_and_b32 v118, v59, v34
    v_and_b32 v119, v59, v35
    s_cmp_gt_u32 s62, 21
    s_cbranch_scc1 L_sk_59
    s_waitcnt vmcnt(5)
    s_cmp_eq_u32 s60, 0
    s_cbranch_scc1 L_dw_60
    s_waitcnt vmcnt(4)
L_dw_60:
    global_load_dwordx4 v[156:159], v5, s[8:9] offset:1024 nt
L_sk_59:
    s_cmp_gt_u32 s62, 22
    s_cbranch_scc1 L_sk_61
    s_waitcnt vmcnt(5)
    s_cmp_eq_u32 s60, 0
    s_cbranch_scc1 L_dw_62
    s_waitcnt vmcnt(4)
L_dw_62:
    global_load_dwordx4 v[160:163], v5, s[8:9] offset:2048 nt
L_sk_61:
    s_cmp_gt_u32 s62, 23
    s_cbranch_scc1 L_sk_63
    s_waitcnt vmcnt(5)
    s_cmp_eq_u32 s60, 0
    s_cbranch_scc1 L_dw_64
    s_waitcnt vmcnt(4)
L_dw_64:
    global_load_dwordx4 v[164:167], v5, s[8:9] offset:3072 nt
L_sk_63:
    s_waitcnt vmcnt(11)
    v_mfma_f32_16x16x32_bf16 v[44:47], v[72:75], v[120:123], 0
    s_waitcnt vmcnt(10)
    v_mfma_f32_16x16x32_bf16 v[44:47], v[76:79], v[124:127], v[44:47]
    s_waitcnt vmcnt(9)
    v_mfma_f32_16x16x32_bf16 v[44:47], v[80:83], v[128:131], v[44:47]
    s_waitcnt vmcnt(8)
    v_mfma_f32_16x16x32_bf16 v[44:47], v[84:87], v[132:135], v[44:47]
    s_waitcnt vmcnt(7)
    v_mfma_f32_16x16x32_bf16 v[44:47], v[88:91], v[136:139], v[44:47]
    s_waitcnt vmcnt(6)
    v_mfma_f32_16x16x32_bf16 v[44:47], v[92:95], v[140:143], v[44:47]
    s_waitcnt vmcnt(5)
    v_mfma_f32_16x16x32_bf16 v[44:47], v[96:99], v[144:147], v[44:47]
    s_waitcnt vmcnt(4)
    v_mfma_f32_16x16x32_bf16 v[44:47], v[100:103], v[148:151], v[44:47]
    s_waitcnt vmcnt(3)
    v_mfma_f32_16x16x32_bf16 v[44:47], v[104:107], v[152:155], v[44:47]
    s_waitcnt vmcnt(2)
    v_mfma_f32_16x16x32_bf16 v[44:47], v[108:111], v[156:159], v[44:47]
    s_waitcnt vmcnt(1)
    v_mfma_f32_16x16x32_bf16 v[44:47], v[112:115], v[160:163], v[44:47]
    s_waitcnt vmcnt(0)
    v_mfma_f32_16x16x32_bf16 v[44:47], v[116:119], v[164:167], v[44:47]
    s_mov_b64 exec, 0xffffffff
    s_nop 7
    ds_write_b128 v37, v[44:47] offset:4096
    ds_write_b32 v38, v42 offset:3328
    s_mov_b64 exec, -1
L_att_fin:
    s_endpgm
L_helper:
    s_mov_b32 s59, 0
    s_lshr_b32 s31, s2, 3
    s_mul_i32 s61, s31, 37
    s_lshr_b32 s61, s61, 8
    s_mul_i32 s33, s61, 7
    s_sub_u32 s31, s31, s33
    s_sub_u32 s33, s60, 1
    s_cmp_eq_u32 s61, 4
    s_cselect_b32 s61, s31, s61
    s_cselect_b32 s31, s33, s31
    s_cselect_b32 s60, 0, s60
    s_lshl_b32 s30, s61, 3
    s_add_u32 s30, s30, s60
    v_mov_b32 v70, v6
    v_lshlrev_b32 v3, 4, v1
    v_lshrrev_b32 v6, 4, v1
    v_and_b32 v7, 15, v1
    v_bfe_u32 v54, v1, 2, 2
    v_lshl_add_u32 v55, v6, 3, v54
    v_lshlrev_b32 v55, 8, v55
    v_and_b32 v56, 3, v1
    v_lshl_add_u32 v55, v56, 3, v55
    v_and_b32 v56, 1, v6
    v_lshl_or_b32 v56, v56, 2, v54
    s_lshl_b32 s34, s29, 2
    v_xor_b32 v56, s34, v56
    v_xor_b32 v57, 0, v56
    v_lshl_add_u32 v60, v57, 5, v55
    v_xor_b32 v57, 1, v56
    v_lshl_add_u32 v61, v57, 5, v55
    v_xor_b32 v57, 2, v56
    v_lshl_add_u32 v62, v57, 5, v55
    v_xor_b32 v57, 3, v56
    v_lshl_add_u32 v63, v57, 5, v55
    v_bfe_u32 v57, v1, 2, 1
    v_mul_u32_u24 v64, 1280, v57
    v_lshl_add_u32 v64, v6, 4, v64
    s_mul_i32 s34, s31, 192
    v_add_u32 v64, s34, v64
    v_lshlrev_b32 v65, 12, v6
    v_lshl_add_u32 v65, v7, 4, v65
    s_lshl_b32 s37, s30, 13
    s_lshl_b32 s35, s31, 9
    s_add_u32 s34, s37, s35
    s_lshl_b32 s35, s29, 8
    s_add_u32 s34, s34, s35
    s_add_u32 s34, s34, 65536
    v_add_u32 v65, s34, v65
    v_min_u32 v66, 9, v7
    v_lshlrev_b32 v66, 2, v66
    s_lshl_b32 s34, s29, 2
    v_mov_b32 v67, s34
    v_mov_b32 v71, 0xff
    s_waitcnt vmcnt(0)
    v_mov_b32 v23, 0x3f803f80
    v_mov_b32 v16, 0
    v_dot2c_f32_bf16 v16, v8, v23
    v_dot2c_f32_bf16 v16, v9, v23
    v_dot2c_f32_bf16 v16, v10, v23
    v_dot2c_f32_bf16 v16, v11, v23
    v_dot2c_f32_bf16 v16, v12, v23
    v_lshlrev_b32 v32, 16, v8
    v_and_b32 v33, 0xffff0000, v8
    v_lshlrev_b32 v34, 16, v9
    v_add_f32_dpp v16, v16, v16 row_ror:8 row_mask:0xf bank_mask:0xf
    v_and_b32 v35, 0xffff0000, v9
    v_lshlrev_b32 v36, 16, v10
    v_add_f32_dpp v16, v16, v16 row_ror:4 row_mask:0xf bank_mask:0xf
    v_and_b32 v37, 0xffff0000, v10
    v_lshlrev_b32 v38, 16, v11
    v_add_f32_dpp v16, v16, v16 row_ror:2 row_mask:0xf bank_mask:0xf
    v_and_b32 v39, 0xffff0000, v11
    v_lshlrev_b32 v40, 16, v12
    v_add_f32_dpp v16, v16, v16 row_ror:1 row_mask:0xf bank_mask:0xf
    v_mov_b32 v17, v16
    v_and_b32 v41, 0xffff0000, v12
    s_nop 0
    v_permlane16_swap_b32 v16, v17
    v_add_f32 v16, v16, v17
    v_mov_b32 v17, v16
    s_nop 1
    v_permlane32_swap_b32 v16, v17
    v_add_f32 v16, v16, v17
    v_mul_f32 v16, 0x3acccccd, v16
    v_cvt_pk_bf16_f32 v18, v16, v16
    v_and_b32 v18, 0xffff0000, v18
    v_sub_f32 v16, v16, v18
    v_pk_add_f32 v[42:43], v[32:33], v[18:19] op_sel_hi:[1,0] neg_lo:[0,1] neg_hi:[0,1]
    v_pk_add_f32 v[44:45], v[34:35], v[18:19] op_sel_hi:[1,0] neg_lo:[0,1] neg_hi:[0,1]
    v_pk_add_f32 v[46:47], v[36:37], v[18:19] op_sel_hi:[1,0] neg_lo:[0,1] neg_hi:[0,1]
    v_pk_add_f32 v[48:49], v[38:39], v[18:19] op_sel_hi:[1,0] neg_lo:[0,1] neg_hi:[0,1]
    v_pk_add_f32 v[50:51], v[40:41], v[18:19] op_sel_hi:[1,0] neg_lo:[0,1] neg_hi:[0,1]
    v_pk_mul_f32 v[20:21], v[42:43], v[42:43]
    v_pk_fma_f32 v[20:21], v[44:45], v[44:45], v[20:21]
    v_pk_fma_f32 v[20:21], v[46:47], v[46:47], v[20:21]
    v_pk_fma_f32 v[20:21], v[48:49], v[48:49], v[20:21]
    v_pk_fma_f32 v[20:21], v[50:51], v[50:51], v[20:21]
    v_add_f32 v20, v20, v21
    v_cvt_pk_bf16_f32 v42, v42, v43
    v_cvt_pk_bf16_f32 v44, v44, v45
    v_add_f32_dpp v20, v20, v20 row_ror:8 row_mask:0xf bank_mask:0xf
    v_cvt_pk_bf16_f32 v46, v46, v47
    v_cvt_pk_bf16_f32 v48, v48, v49
    v_add_f32_dpp v20, v20, v20 row_ror:4 row_mask:0xf bank_mask:0xf
    v_cvt_pk_bf16_f32 v50, v50, v51
    v_lshlrev_b32 v32, 16, v42
    v_add_f32_dpp v20, v20, v20 row_ror:2 row_mask:0xf bank_mask:0xf
    v_and_b32 v33, 0xffff0000, v42
    v_lshlrev_b32 v34, 16, v44
    v_add_f32_dpp v20, v20, v20 row_ror:1 row_mask:0xf bank_mask:0xf
    v_mov_b32 v21, v20
    v_and_b32 v35, 0xffff0000, v44
    v_lshlrev_b32 v36, 16, v46
    v_permlane16_swap_b32 v20, v21
    v_add_f32 v20, v20, v21
    v_mov_b32 v21, v20
    v_and_b32 v37, 0xffff0000, v46
    v_lshlrev_b32 v38, 16, v48
    v_permlane32_swap_b32 v20, v21
    v_add_f32 v20, v20, v21
    v_mul_f32 v20, 0x3acccccd, v20
    v_fma_f32 v20, -v16, v16, v20
    v_max_f32 v20, 0, v20
    v_cvt_pk_bf16_f32 v20, v20, v20
    v_and_b32 v20, 0xffff0000, v20
    v_add_f32 v20, 0x3727c5ac, v20
    v_cvt_pk_bf16_f32 v20, v20, v20
    v_and_b32 v20, 0xffff0000, v20
    v_sqrt_f32 v20, v20
    v_and_b32 v39, 0xffff0000, v48
    v_cvt_pk_bf16_f32 v20, v20, v20
    v_and_b32 v20, 0xffff0000, v20
    v_rcp_f32 v22, v20
    v_lshlrev_b32 v40, 16, v50
    v_and_b32 v41, 0xffff0000, v50
    v_fma_f32 v21, -v20, v22, 1.0
    v_fma_f32 v22, v21, v22, v22
    v_pk_mul_f32 v[32:33], v[32:33], v[22:23] op_sel_hi:[1,0]
    v_pk_mul_f32 v[34:35], v[34:35], v[22:23] op_sel_hi:[1,0]
    v_pk_mul_f32 v[36:37], v[36:37], v[22:23] op_sel_hi:[1,0]
    v_pk_mul_f32 v[38:39], v[38:39], v[22:23] op_sel_hi:[1,0]
    v_pk_mul_f32 v[40:41], v[40:41], v[22:23] op_sel_hi:[1,0]
    v_cvt_pk_bf16_f32 v42, v32, v33
    v_cvt_pk_bf16_f32 v43, v34, v35
    v_cvt_pk_bf16_f32 v44, v36, v37
    v_cvt_pk_bf16_f32 v45, v38, v39
    v_cvt_pk_bf16_f32 v46, v40, v41
    ds_write_b32 v70, v42 offset:0
    ds_write_b32 v70, v43 offset:256
    ds_write_b32 v70, v44 offset:512
    ds_write_b32 v70, v45 offset:768
    ds_write_b32 v70, v46 offset:1024
    v_mov_b32 v68, 1
    ds_write_b32 v67, v68 offset:3104
L_f1poll:
    s_add_u32 s59, s59, 1
    s_cmp_gt_u32 s59, 1048576
    s_cbranch_scc1 L_end
    ds_read_b32 v69, v66 offset:3072
    s_waitcnt lgkmcnt(0)
    v_cmp_eq_u32 vcc, 1, v69
    s_cmp_eq_u64 vcc, -1
    s_cbranch_scc0 L_f1poll
    ds_read_b128 v[120:123], v64 offset:0
    ds_read_b64_tr_b16 v[72:73], v60 offset:8192
    ds_read_b64_tr_b16 v[74:75], v60 offset:9216
    ds_read_b64_tr_b16 v[84:85], v61 offset:8192
    ds_read_b64_tr_b16 v[86:87], v61 offset:9216
    ds_read_b64_tr_b16 v[96:97], v62 offset:8192
    ds_read_b64_tr_b16 v[98:99], v62 offset:9216
    ds_read_b64_tr_b16 v[108:109], v63 offset:8192
    ds_read_b64_tr_b16 v[110:111], v63 offset:9216
    s_add_u32 s28, s28, 2654435769
    s_and_b32 s44, s28, 0xff
    s_bfe_u32 s45, s28, 0x80008
    s_bfe_u32 s46, s28, 0x80010
    s_lshr_b32 s47, s28, 24
    ds_read_b128 v[124:127], v64 offset:64
    ds_read_b64_tr_b16 v[76:77], v60 offset:16384
    ds_read_b64_tr_b16 v[78:79], v60 offset:17408
    ds_read_b64_tr_b16 v[88:89], v61 offset:16384
    ds_read_b64_tr_b16 v[90:91], v61 offset:17408
    ds_read_b64_tr_b16 v[100:101], v62 offset:16384
    ds_read_b64_tr_b16 v[102:103], v62 offset:17408
    ds_read_b64_tr_b16 v[112:113], v63 offset:16384
    ds_read_b64_tr_b16 v[114:115], v63 offset:17408
    s_cmp_eq_u32 s31, 6
    s_cbranch_scc1 L_q2
    s_waitcnt lgkmcnt(9)
    ds_read_b128 v[128:131], v64 offset:128
    ds_read_b64_tr_b16 v[80:81], v60 offset:24576
    ds_read_b64_tr_b16 v[82:83], v60 offset:25600
    ds_read_b64_tr_b16 v[92:93], v61 offset:24576
    ds_read_b64_tr_b16 v[94:95], v61 offset:25600
    ds_read_b64_tr_b16 v[104:105], v62 offset:24576
    ds_read_b64_tr_b16 v[106:107], v62 offset:25600
    ds_read_b64_tr_b16 v[116:117], v63 offset:24576
    ds_read_b64_tr_b16 v[118:119], v63 offset:25600
    v_mfma_f32_16x16x32_bf16 v[132:135], v[120:123], v[72:75], 0
    v_mfma_f32_16x16x32_bf16 v[136:139], v[120:123], v[84:87], 0
    v_mfma_f32_16x16x32_bf16 v[140:143], v[120:123], v[96:99], 0
    v_mfma_f32_16x16x32_bf16 v[144:147], v[120:123], v[108:111], 0
    s_waitcnt lgkmcnt(9)
    v_mfma_f32_16x16x32_bf16 v[132:135], v[124:127], v[76:79], v[132:135]
    v_mfma_f32_16x16x32_bf16 v[136:139], v[124:127], v[88:91], v[136:139]
    v_mfma_f32_16x16x32_bf16 v[140:143], v[124:127], v[100:103], v[140:143]
    v_mfma_f32_16x16x32_bf16 v[144:147], v[124:127], v[112:115], v[144:147]
    s_waitcnt lgkmcnt(0)
    v_mfma_f32_16x16x32_bf16 v[132:135], v[128:131], v[80:83], v[132:135]
    v_mfma_f32_16x16x32_bf16 v[136:139], v[128:131], v[92:95], v[136:139]
    v_mfma_f32_16x16x32_bf16 v[140:143], v[128:131], v[104:107], v[140:143]
    v_mfma_f32_16x16x32_bf16 v[144:147], v[128:131], v[116:119], v[144:147]
    s_branch L_q3
L_q2:
    s_waitcnt lgkmcnt(9)
    v_mfma_f32_16x16x32_bf16 v[132:135], v[120:123], v[72:75], 0
    v_mfma_f32_16x16x32_bf16 v[136:139], v[120:123], v[84:87], 0
    v_mfma_f32_16x16x32_bf16 v[140:143], v[120:123], v[96:99], 0
    v_mfma_f32_16x16x32_bf16 v[144:147], v[120:123], v[108:111], 0
    s_waitcnt lgkmcnt(0)
    v_mfma_f32_16x16x32_bf16 v[132:135], v[124:127], v[76:79], v[132:135]
    v_mfma_f32_16x16x32_bf16 v[136:139], v[124:127], v[88:91], v[136:139]
    v_mfma_f32_16x16x32_bf16 v[140:143], v[124:127], v[100:103], v[140:143]
    v_mfma_f32_16x16x32_bf16 v[144:147], v[124:127], v[112:115], v[144:147]
L_q3:
    s_mov_b64 exec, 0xffffffff
    s_nop 3
    v_bfi_b32 v12, v71, s44, v132
    v_bfi_b32 v13, v71, s45, v136
    v_bfi_b32 v14, v71, s46, v140
    v_bfi_b32 v15, v71, s47, v144
    global_store_dwordx4 v65, v[12:15], s[26:27] sc1
    s_mov_b64 exec, -1
    s_lshr_b32 s32, s31, 1
    s_and_b32 s33, s31, 1
    s_sub_u32 s34, s31, 5
    s_cmp_ge_u32 s31, 5
    s_cselect_b32 s32, s34, s32
    s_cselect_b32 s33, 3, s33
    s_cmp_eq_u32 s31, 4
    s_cselect_b32 s32, s29, s32
    s_cselect_b32 s33, 2, s33
    s_cselect_b32 s39, 0, s29
    v_and_b32 v58, 7, v1
    v_lshlrev_b32 v59, 2, v58
    v_lshl_add_u32 v52, v6, 3, v54
    v_lshlrev_b32 v52, 6, v52
    v_and_b32 v53, 3, v1
    v_lshl_add_u32 v52, v53, 3, v52
    s_lshl_b32 s34, s29, 5
    s_add_u32 s34, s34, 32768
    v_add_u32 v52, s34, v52
    v_bfe_u32 v55, v1, 2, 1
    v_lshlrev_b32 v53, 10, v55
    v_lshl_add_u32 v53, v6, 4, v53
    v_and_b32 v55, 1, v1
    v_lshl_add_u32 v53, v55, 9, v53
    v_mov_b32 v50, 0x44444444
    v_mov_b32 v51, 0xeeeeeeee
    v_cmp_eq_u32 vcc, 1, v55
    v_and_b32 v49, 3, v1
    v_lshlrev_b32 v49, 3, v49
    v_cndmask_b32 v50, v50, v51, vcc
    v_lshrrev_b32 v49, v49, s28
    v_lshlrev_b32 v55, 2, v1
    s_mul_i32 s34, s61, 5
    s_add_u32 s34, s34, s31
    s_lshl_b32 s34, s34, 8
    s_lshl_b32 s35, s29, 7
    s_add_u32 s34, s34, s35
    s_mul_i32 s35, s60, 5120
    s_add_u32 s34, s34, s35
    s_add_u32 s34, s34, 16384
    v_add_u32 v55, s34, v55
    s_cmp_lg_u32 s39, 0
    s_cbranch_scc1 L_h_passive
    s_lshl_b32 s35, s32, 12
    s_add_u32 s35, s35, s37
    s_add_u32 s35, s35, 65536
    v_add_u32 v56, s35, v3
    s_add_u32 s56, s26, s35
    s_addc_u32 s57, s27, 0
    s_lshl_b32 s34, s60, 2
    s_add_u32 s34, s34, s61
    s_lshl_b32 s34, s34, 1
    s_add_u32 s34, s34, s32
    s_lshl_b32 s34, s34, 2
    s_add_u32 s34, s34, s33
    s_lshl_b32 s35, s34, 9
    s_add_u32 s35, s35, 327680
    v_lshlrev_b32 v63, 3, v1
    v_add_u32 v60, s35, v63
    s_lshl_b32 s35, s34, 7
    s_add_u32 s35, s35, 753664
    v_add_u32 v69, s35, v3
    v_lshlrev_b32 v61, 4, v58
    s_lshl_b32 s34, s29, 4
    v_mov_b32 v62, s34
    v_and_b32 v64, 1, v6
    v_lshlrev_b32 v64, 7, v64
    v_lshrrev_b32 v57, 5, v1
    v_lshl_add_u32 v64, v57, 5, v64
    v_lshl_add_u32 v64, v7, 1, v64
    s_lshl_b32 s34, s29, 8
    v_add_u32 v64, s34, v64
    v_mov_b32 v84, 0
    v_mov_b32 v85, 0
    v_mov_b32 v86, 0
    v_mov_b32 v87, 0
    s_sleep 8
    s_and_b32 s58, s47, 0xff
L_qhint:
    s_add_u32 s59, s59, 1
    s_cmp_gt_u32 s59, 1048576
    s_cbranch_scc1 L_end
    s_load_dword s40, s[56:57], 252 glc
    s_load_dword s41, s[56:57], 508 glc
    s_load_dword s42, s[56:57], 764 glc
    s_load_dword s43, s[56:57], 1020 glc
    s_load_dword s48, s[56:57], 1276 glc
    s_load_dword s49, s[56:57], 1532 glc
    s_load_dword s50, s[56:57], 1788 glc
    s_load_dword s51, s[56:57], 2044 glc
    s_load_dword s52, s[56:57], 2300 glc
    s_load_dword s53, s[56:57], 2556 glc
    s_load_dword s54, s[56:57], 2812 glc
    s_load_dword s55, s[56:57], 3068 glc
    s_load_dword s62, s[56:57], 3324 glc
    s_load_dword s63, s[56:57], 3580 glc
    s_waitcnt lgkmcnt(0)
    s_xor_b32 s40, s40, s58
    s_xor_b32 s41, s41, s58
    s_or_b32 s40, s40, s41
    s_xor_b32 s42, s42, s58
    s_or_b32 s40, s40, s42
    s_xor_b32 s43, s43, s58
    s_or_b32 s40, s40, s43
    s_xor_b32 s48, s48, s58
    s_or_b32 s40, s40, s48
    s_xor_b32 s49, s49, s58
    s_or_b32 s40, s40, s49
    s_xor_b32 s50, s50, s58
    s_or_b32 s40, s40, s50
    s_xor_b32 s51, s51, s58
    s_or_b32 s40, s40, s51
    s_xor_b32 s52, s52, s58
    s_or_b32 s40, s40, s52
    s_xor_b32 s53, s53, s58
    s_or_b32 s40, s40, s53
    s_xor_b32 s54, s54, s58
    s_or_b32 s40, s40, s54
    s_xor_b32 s55, s55, s58
    s_or_b32 s40, s40, s55
    s_xor_b32 s62, s62, s58
    s_or_b32 s40, s40, s62
    s_xor_b32 s63, s63, s58
    s_or_b32 s40, s40, s63
    s_and_b32 s40, s40, 0xff
    s_cbranch_scc1 L_qhint
    s_mov_b32 s40, -1
    s_mov_b32 s41, -1
    s_mov_b32 s42, -1
    s_mov_b32 s43, -1
    s_mov_b32 s48, -1
    s_mov_b32 s49, -1
    s_mov_b32 s50, -1
    s_mov_b32 s51, 0
L_qpoll:
    s_add_u32 s59, s59, 1
    s_cmp_gt_u32 s59, 1048576
    s_cbranch_scc1 L_end
    s_mov_b64 exec, s[40:41]
    global_load_dwordx4 v[72:75], v56, s[26:27] offset:0 sc1
    s_mov_b64 exec, s[42:43]
    global_load_dwordx4 v[76:79], v56, s[26:27] offset:1024 sc1
    s_mov_b64 exec, s[48:49]
    global_load_dwordx4 v[80:83], v56, s[26:27] offset:2048 sc1
    s_mov_b64 exec, s[50:51]
    global_load_dwordx4 v[84:87], v56, s[26:27] offset:3072 sc1
    s_mov_b64 exec, s[40:41]
    s_waitcnt vmcnt(3)
    v_xor_b32 v72, s44, v72
    v_xor_b32 v73, s45, v73
    v_xor_b32 v74, s46, v74
    v_xor_b32 v75, s47, v75
    v_or3_b32 v13, v72, v73, v74
    v_or_b32 v13, v13, v75
    v_cmp_ne_u32_sdwa s[40:41], v13, 0 src0_sel:BYTE_0 src1_sel:DWORD
    s_mov_b64 exec, s[42:43]
    s_waitcnt vmcnt(2)
    v_xor_b32 v76, s44, v76
    v_xor_b32 v77, s45, v77
    v_xor_b32 v78, s46, v78
    v_xor_b32 v79, s47, v79
    v_or3_b32 v13, v76, v77, v78
    v_or_b32 v13, v13, v79
    v_cmp_ne_u32_sdwa s[42:43], v13, 0 src0_sel:BYTE_0 src1_sel:DWORD
    s_mov_b64 exec, s[48:49]
    s_waitcnt vmcnt(1)
    v_xor_b32 v80, s44, v80
    v_xor_b32 v81, s45, v81
    v_xor_b32 v82, s46, v82
    v_xor_b32 v83, s47, v83
    v_or3_b32 v13, v80, v81, v82
    v_or_b32 v13, v13, v83
    v_cmp_ne_u32_sdwa s[48:49], v13, 0 src0_sel:BYTE_0 src1_sel:DWORD
    s_mov_b64 exec, s[50:51]
    s_waitcnt vmcnt(0)
    v_xor_b32 v84, s44, v84
    v_xor_b32 v85, s45, v85
    v_xor_b32 v86, s46, v86
    v_xor_b32 v87, s47, v87
    v_or3_b32 v13, v84, v85, v86
    v_or_b32 v13, v13, v87
    v_cmp_ne_u32_sdwa s[50:51], v13, 0 src0_sel:BYTE_0 src1_sel:DWORD
    s_mov_b64 exec, -1
    s_wqm_b64 s[40:41], s[40:41]
    s_wqm_b64 s[42:43], s[42:43]
    s_wqm_b64 s[48:49], s[48:49]
    s_wqm_b64 s[50:51], s[50:51]
    s_or_b64 vcc, s[40:41], s[42:43]
    s_or_b64 vcc, vcc, s[48:49]
    s_or_b64 vcc, vcc, s[50:51]
    s_cbranch_scc1 L_qpoll
    v_pk_add_f32 v[72:73], v[72:73], v[76:77]
    v_pk_add_f32 v[74:75], v[74:75], v[78:79]
    v_pk_add_f32 v[80:81], v[80:81], v[84:85]
    v_pk_add_f32 v[82:83], v[82:83], v[86:87]
    v_pk_add_f32 v[72:73], v[72:73], v[80:81]
    v_pk_add_f32 v[74:75], v[74:75], v[82:83]
    s_nop 0
    v_permlane32_swap_b32 v72, v73
    v_permlane32_swap_b32 v74, v75
    v_add_f32 v72, v72, v73
    v_add_f32 v74, v74, v75
    v_cvt_pk_bf16_f32 v12, v72, v74
    ds_write_b16 v64, v12 offset:2560
    ds_write_b16_d16_hi v64, v12 offset:2624
L_qdone:
    ds_write_b32 v62, v68 offset:3136
    v_lshrrev_b32 v24, 2, v58
    v_cmp_eq_u32 s[48:49], s29, v24
    s_cmp_eq_u32 s31, 4
    s_cselect_b64 s[48:49], s[48:49], -1
    v_and_b32 v24, 1, v1
    v_lshlrev_b32 v24, 4, v24
    v_lshrrev_b32 v26, v24, s28
    v_lshrrev_b32 v27, 8, v26
    s_getreg_b32 s34, hwreg(HW_REG_XCC_ID)
    v_mov_b32 v18, s34
    v_mov_b32 v19, s28
    v_add_u32 v28, 131072, v60
    v_mov_b32 v25, 0xff7fffff
L_spoll:
    s_add_u32 s59, s59, 1
    s_cmp_gt_u32 s59, 1048576
    s_cbranch_scc1 L_end
    s_sleep 1
    ds_read_b128 v[20:23], v61 offset:3200
    s_waitcnt lgkmcnt(0)
    v_cmp_eq_u32 vcc, 1, v22
    s_cmp_eq_u64 vcc, -1
    s_cbranch_scc0 L_spoll
    v_cndmask_b32 v20, v25, v20, s[48:49]
    s_nop 1
    v_max_f32_dpp v16, v20, v20 quad_perm:[1,0,3,2] row_mask:0xf bank_mask:0xf
    s_nop 1
    v_max_f32_dpp v16, v16, v16 quad_perm:[2,3,0,1] row_mask:0xf bank_mask:0xf
    s_nop 1
    v_max_f32_dpp v16, v16, v16 row_ror:4 row_mask:0xf bank_mask:0xf
    v_sub_f32 v20, v20, v16
    v_exp_f32 v20, v20
    s_nop 0
    v_mul_f32 v17, v21, v20
    v_mov_b32_dpp v136, v20 row_newbcast:0 row_mask:0xf bank_mask:0xf
    v_mov_b32_dpp v138, v20 row_newbcast:1 row_mask:0xf bank_mask:0xf
    v_add_f32_dpp v17, v17, v17 quad_perm:[1,0,3,2] row_mask:0xf bank_mask:0xf
    v_mov_b32_dpp v140, v20 row_newbcast:2 row_mask:0xf bank_mask:0xf
    v_mov_b32_dpp v142, v20 row_newbcast:3 row_mask:0xf bank_mask:0xf
    v_add_f32_dpp v17, v17, v17 quad_perm:[2,3,0,1] row_mask:0xf bank_mask:0xf
    v_mov_b32_dpp v144, v20 row_newbcast:4 row_mask:0xf bank_mask:0xf
    v_mov_b32_dpp v146, v20 row_newbcast:5 row_mask:0xf bank_mask:0xf
    v_add_f32_dpp v17, v17, v17 row_ror:4 row_mask:0xf bank_mask:0xf
    v_mov_b32_dpp v148, v20 row_newbcast:6 row_mask:0xf bank_mask:0xf
    v_mov_b32_dpp v150, v20 row_newbcast:7 row_mask:0xf bank_mask:0xf
    s_mov_b64 exec, 0xff
    global_store_dwordx4 v69, v[16:19], s[26:27] sc1
    s_mov_b64 exec, -1
L_opart:
    s_add_u32 s59, s59, 1
    s_cmp_gt_u32 s59, 1048576
    s_cbranch_scc1 L_end
    ds_read_b32 v20, v59 offset:3328
    ds_read_b64 v[72:73], v63 offset:4096
    ds_read_b64 v[74:75], v63 offset:4608
    ds_read_b64 v[76:77], v63 offset:5120
    ds_read_b64 v[78:79], v63 offset:5632
    ds_read_b64 v[80:81], v63 offset:6144
    ds_read_b64 v[82:83], v63 offset:6656
    ds_read_b64 v[84:85], v63 offset:7168
    ds_read_b64 v[86:87], v63 offset:7680
    s_waitcnt lgkmcnt(8)
    v_cmp_eq_u32 vcc, 1, v20
    s_cmp_eq_u64 vcc, -1
    s_cbranch_scc0 L_opart
    s_waitcnt lgkmcnt(6)
    v_pk_mul_f32 v[12:13], v[72:73], v[136:137] op_sel_hi:[1,0]
    v_pk_mul_f32 v[14:15], v[74:75], v[138:139] op_sel_hi:[1,0]
    s_waitcnt lgkmcnt(4)
    v_pk_fma_f32 v[12:13], v[76:77], v[140:141], v[12:13] op_sel_hi:[1,0,1]
    v_pk_fma_f32 v[14:15], v[78:79], v[142:143], v[14:15] op_sel_hi:[1,0,1]
    s_waitcnt lgkmcnt(2)
    v_pk_fma_f32 v[12:13], v[80:81], v[144:145], v[12:13] op_sel_hi:[1,0,1]
    v_pk_fma_f32 v[14:15], v[82:83], v[146:147], v[14:15] op_sel_hi:[1,0,1]
    s_waitcnt lgkmcnt(0)
    v_pk_fma_f32 v[12:13], v[84:85], v[148:149], v[12:13] op_sel_hi:[1,0,1]
    v_pk_fma_f32 v[14:15], v[86:87], v[150:151], v[14:15] op_sel_hi:[1,0,1]
    v_pk_add_f32 v[12:13], v[12:13], v[14:15]
    v_bfi_b32 v12, v71, v26, v12
    v_bfi_b32 v13, v71, v27, v13
    global_store_dwordx2 v28, v[12:13], s[26:27]
    global_store_dwordx2 v60, v[12:13], s[26:27] sc1
L_h_passive:
    s_cmp_lt_u32 s31, 5
    s_cbranch_scc1 L_wf
    s_lshl_b32 s36, s30, 1
    s_add_u32 s36, s36, s31
    s_sub_u32 s36, s36, 5
    s_cmp_lg_u32 s29, 0
    s_cselect_b32 s36, 99, s36
    s_branch L_h_end
L_wf:
    s_add_u32 s59, s59, 1
    s_cmp_gt_u32 s59, 1048576
    s_cbranch_scc1 L_end
    s_sleep 1
    ds_read_b32 v20, v59 offset:3360
    s_waitcnt lgkmcnt(0)
    v_cmp_eq_u32 vcc, 1, v20
    s_cmp_eq_u64 vcc, -1
    s_cbranch_scc0 L_wf
    ds_read_b64_tr_b16 v[72:73], v52 offset:0
    ds_read_b64_tr_b16 v[74:75], v52 offset:256
    ds_read_b64_tr_b16 v[76:77], v52 offset:2048
    ds_read_b64_tr_b16 v[78:79], v52 offset:2304
    ds_read_b64_tr_b16 v[80:81], v52 offset:4096
    ds_read_b64_tr_b16 v[82:83], v52 offset:4352
    ds_read_b64_tr_b16 v[84:85], v52 offset:6144
    ds_read_b64_tr_b16 v[86:87], v52 offset:6400
    ds_read_b64_tr_b16 v[88:89], v52 offset:8192
    ds_read_b64_tr_b16 v[90:91], v52 offset:8448
    ds_read_b64_tr_b16 v[92:93], v52 offset:10240
    ds_read_b64_tr_b16 v[94:95], v52 offset:10496
    ds_read_b64_tr_b16 v[96:97], v52 offset:12288
    ds_read_b64_tr_b16 v[98:99], v52 offset:12544
    ds_read_b64_tr_b16 v[100:101], v52 offset:14336
    ds_read_b64_tr_b16 v[102:103], v52 offset:14592
    ds_read_b64_tr_b16 v[104:105], v52 offset:16384
    ds_read_b64_tr_b16 v[106:107], v52 offset:16640
    ds_read_b64_tr_b16 v[108:109], v52 offset:18432
    ds_read_b64_tr_b16 v[110:111], v52 offset:18688
    ds_read_b64_tr_b16 v[112:113], v52 offset:20480
    ds_read_b64_tr_b16 v[114:115], v52 offset:20736
    ds_read_b64_tr_b16 v[116:117], v52 offset:22528
    ds_read_b64_tr_b16 v[118:119], v52 offset:22784
    ds_read_b64_tr_b16 v[120:121], v52 offset:24576
    ds_read_b64_tr_b16 v[122:123], v52 offset:24832
    ds_read_b64_tr_b16 v[124:125], v52 offset:26624
    ds_read_b64_tr_b16 v[126:127], v52 offset:26880
    ds_read_b64_tr_b16 v[128:129], v52 offset:28672
    ds_read_b64_tr_b16 v[130:131], v52 offset:28928
    ds_read_b64_tr_b16 v[132:133], v52 offset:30720
    ds_read_b64_tr_b16 v[134:135], v52 offset:30976
    v_mov_b32 v40, 0
    v_mov_b32 v41, 0
    v_mov_b32 v42, 0
    v_mov_b32 v43, 0
    v_mov_b32 v44, 0
    v_mov_b32 v45, 0
    v_mov_b32 v46, 0
    v_mov_b32 v47, 0
    s_waitcnt lgkmcnt(0)
    s_barrier
    ds_read_b128 v[8:11], v53 offset:8192
    ds_read_b128 v[12:15], v53 offset:8256
    ds_read_b128 v[16:19], v53 offset:8320
    ds_read_b128 v[20:23], v53 offset:8384
    ds_read_b128 v[24:27], v53 offset:8448
    ds_read_b128 v[28:31], v53 offset:8512
    ds_read_b128 v[32:35], v53 offset:8576
    ds_read_b128 v[36:39], v53 offset:8640
    s_waitcnt lgkmcnt(7)
    v_smfmac_f32_16x16x64_bf16 v[40:43], v[8:11], v[72:79], v50
    s_waitcnt lgkmcnt(6)
    v_smfmac_f32_16x16x64_bf16 v[44:47], v[12:15], v[80:87], v50
    s_waitcnt lgkmcnt(5)
    v_smfmac_f32_16x16x64_bf16 v[40:43], v[16:19], v[88:95], v50
    s_waitcnt lgkmcnt(4)
    v_smfmac_f32_16x16x64_bf16 v[44:47], v[20:23], v[96:103], v50
    s_waitcnt lgkmcnt(3)
    v_smfmac_f32_16x16x64_bf16 v[40:43], v[24:27], v[104:111], v50
    s_waitcnt lgkmcnt(2)
    v_smfmac_f32_16x16x64_bf16 v[44:47], v[28:31], v[112:119], v50
    s_waitcnt lgkmcnt(1)
    v_smfmac_f32_16x16x64_bf16 v[40:43], v[32:35], v[120:127], v50
    s_waitcnt lgkmcnt(0)
    v_smfmac_f32_16x16x64_bf16 v[44:47], v[36:39], v[128:135], v50
    s_mov_b64 exec, 0xffffffff
    s_nop 5
    v_add_f32 v40, v40, v41
    v_add_f32 v44, v44, v45
    v_add_f32 v40, v40, v44
    v_bfi_b32 v40, v71, v49, v40
    global_store_dword v55, v40, s[26:27] sc1
L_h_end:
    s_endpgm
L_shead:
    s_lshr_b32 s31, s2, 3
    s_cmp_ge_u32 s31, 27
    s_cbranch_scc1 L_warm
    v_lshrrev_b32 v4, 3, v1
    v_and_b32 v5, 7, v1
    v_mul_u32_u24 v20, 3456, v4
    v_lshl_add_u32 v20, v5, 4, v20
    v_add_u32 v21, 26624, v20
    v_add_u32 v22, 53248, v20
    v_add_u32 v23, 79872, v20
    s_cmp_ge_u32 s29, 8
    s_cbranch_scc1 L_service
    s_mul_i32 s38, s29, 12288
    s_add_u32 s38, s38, 12288
    s_lshr_b32 s32, s29, 1
    s_mul_i32 s34, s32, 552960
    s_lshl_b32 s35, s31, 7
    s_add_u32 s34, s34, s35
    s_bitcmp1_b32 s29, 0
    s_waitcnt lgkmcnt(0)
    s_cselect_b32 s16, s18, s16
    s_cselect_b32 s17, s19, s17
    s_add_u32 s16, s16, s34
    s_addc_u32 s17, s17, 0
    s_mov_b32 m0, s38
    s_nop 0
    global_load_lds_dwordx4 v20, s[16:17] offset:0 nt
    global_load_lds_dwordx4 v21, s[16:17] offset:1024 nt
    global_load_lds_dwordx4 v22, s[16:17] offset:2048 nt
    global_load_lds_dwordx4 v23, s[16:17] offset:3072 nt
    s_add_u32 s16, s16, 110592
    s_addc_u32 s17, s17, 0
    s_add_u32 s39, s38, 4096
    s_mov_b32 m0, s39
    s_nop 0
    global_load_lds_dwordx4 v20, s[16:17] offset:0 nt
    global_load_lds_dwordx4 v21, s[16:17] offset:1024 nt
    global_load_lds_dwordx4 v22, s[16:17] offset:2048 nt
    global_load_lds_dwordx4 v23, s[16:17] offset:3072 nt
    s_add_u32 s16, s16, 110592
    s_addc_u32 s17, s17, 0
    s_add_u32 s39, s38, 8192
    s_mov_b32 m0, s39
    s_nop 0
    global_load_lds_dwordx4 v20, s[16:17] offset:0 nt
    global_load_lds_dwordx4 v21, s[16:17] offset:1024 nt
    global_load_lds_dwordx4 v22, s[16:17] offset:2048 nt
    global_load_lds_dwordx4 v23, s[16:17] offset:3072 nt
    s_add_u32 s16, s16, 110592
    s_addc_u32 s17, s17, 0
    s_branch L_service
L_service:
    s_mov_b32 s59, 0
    v_lshrrev_b32 v8, 4, v1
    v_lshrrev_b32 v4, 3, v1
    v_and_b32 v5, 7, v1
    v_mul_u32_u24 v24, 1280, v4
    v_lshl_add_u32 v24, v5, 4, v24
    v_add_u32 v25, 9216, v24
    v_add_u32 v26, 18432, v24
    v_add_u32 v27, 27648, v24
    s_mul_i32 s38, s29, 12288
    s_add_u32 s38, s38, 12288
    v_bfe_u32 v9, v1, 2, 2
    v_lshl_add_u32 v9, v8, 3, v9
    v_lshlrev_b32 v9, 7, v9
    v_and_b32 v10, 3, v1
    v_lshl_add_u32 v9, v10, 3, v9
    v_add_u32 v9, s38, v9
    s_lshr_b32 s32, s29, 1
    s_mul_i32 s35, s31, 81920
    s_lshl_b32 s36, s29, 7
    s_add_u32 s35, s35, s36
    s_mov_b32 s62, -1
    s_waitcnt lgkmcnt(0)
    s_add_u32 s20, s20, s35
    s_addc_u32 s21, s21, 0
    s_cmp_ge_u32 s29, 8
    s_cbranch_scc1 L_ffn_ln
    s_load_dword s28, s[26:27], 0
    s_waitcnt vmcnt(8)
    ds_read_b64_tr_b16 v[64:65], v9 offset:0
    ds_read_b64_tr_b16 v[66:67], v9 offset:512
    ds_read_b64_tr_b16 v[72:73], v9 offset:32
    ds_read_b64_tr_b16 v[74:75], v9 offset:544
    ds_read_b64_tr_b16 v[80:81], v9 offset:64
    ds_read_b64_tr_b16 v[82:83], v9 offset:576
    ds_read_b64_tr_b16 v[88:89], v9 offset:96
    ds_read_b64_tr_b16 v[90:91], v9 offset:608
    s_waitcnt lgkmcnt(0)
    s_mov_b32 m0, s38
    s_nop 0
    global_load_lds_dwordx4 v20, s[16:17] offset:0 nt
    global_load_lds_dwordx4 v21, s[16:17] offset:1024 nt
    global_load_lds_dwordx4 v22, s[16:17] offset:2048 nt
    global_load_lds_dwordx4 v23, s[16:17] offset:3072 nt
    s_add_u32 s16, s16, 110592
    s_addc_u32 s17, s17, 0
    s_waitcnt vmcnt(8)
    ds_read_b64_tr_b16 v[68:69], v9 offset:4096
    ds_read_b64_tr_b16 v[70:71], v9 offset:4608
    ds_read_b64_tr_b16 v[76:77], v9 offset:4128
    ds_read_b64_tr_b16 v[78:79], v9 offset:4640
    ds_read_b64_tr_b16 v[84:85], v9 offset:4160
    ds_read_b64_tr_b16 v[86:87], v9 offset:4672
    ds_read_b64_tr_b16 v[92:93], v9 offset:4192
    ds_read_b64_tr_b16 v[94:95], v9 offset:4704
    s_waitcnt lgkmcnt(0)
    s_add_u32 s39, s38, 4096
    s_mov_b32 m0, s39
    s_nop 0
    global_load_lds_dwordx4 v20, s[16:17] offset:0 nt
    global_load_lds_dwordx4 v21, s[16:17] offset:1024 nt
    global_load_lds_dwordx4 v22, s[16:17] offset:2048 nt
    global_load_lds_dwordx4 v23, s[16:17] offset:3072 nt
    s_add_u32 s16, s16, 110592
    s_addc_u32 s17, s17, 0
    s_waitcnt vmcnt(8)
    ds_read_b64_tr_b16 v[96:97], v9 offset:8192
    ds_read_b64_tr_b16 v[98:99], v9 offset:8704
    ds_read_b64_tr_b16 v[104:105], v9 offset:8224
    ds_read_b64_tr_b16 v[106:107], v9 offset:8736
    ds_read_b64_tr_b16 v[112:113], v9 offset:8256
    ds_read_b64_tr_b16 v[114:115], v9 offset:8768
    ds_read_b64_tr_b16 v[120:121], v9 offset:8288
    ds_read_b64_tr_b16 v[122:123], v9 offset:8800
    s_waitcnt lgkmcnt(0)
    s_add_u32 s39, s38, 8192
    s_mov_b32 m0, s39
    s_nop 0
    global_load_lds_dwordx4 v24, s[20:21] offset:0 nt
    global_load_lds_dwordx4 v25, s[20:21] offset:1024 nt
    global_load_lds_dwordx4 v26, s[20:21] offset:2048 nt
    global_load_lds_dwordx4 v27, s[20:21] offset:3072 nt
    s_add_u32 s20, s20, 40960
    s_addc_u32 s21, s21, 0
    s_waitcnt vmcnt(8)
    ds_read_b64_tr_b16 v[100:101], v9 offset:0
    ds_read_b64_tr_b16 v[102:103], v9 offset:512
    ds_read_b64_tr_b16 v[108:109], v9 offset:32
    ds_read_b64_tr_b16 v[110:111], v9 offset:544
    ds_read_b64_tr_b16 v[116:117], v9 offset:64
    ds_read_b64_tr_b16 v[118:119], v9 offset:576
    ds_read_b64_tr_b16 v[124:125], v9 offset:96
    ds_read_b64_tr_b16 v[126:127], v9 offset:608
    s_waitcnt lgkmcnt(0)
    s_mov_b32 m0, s38
    s_nop 0
    global_load_lds_dwordx4 v24, s[20:21] offset:0 nt
    global_load_lds_dwordx4 v25, s[20:21] offset:1024 nt
    global_load_lds_dwordx4 v26, s[20:21] offset:2048 nt
    global_load_lds_dwordx4 v27, s[20:21] offset:3072 nt
    s_add_u32 s20, s20, 40960
    s_addc_u32 s21, s21, 0
    s_barrier
    s_waitcnt vmcnt(8)
    ds_read_b64_tr_b16 v[128:129], v9 offset:4096
    ds_read_b64_tr_b16 v[130:131], v9 offset:4608
    ds_read_b64_tr_b16 v[132:133], v9 offset:4128
    ds_read_b64_tr_b16 v[134:135], v9 offset:4640
    ds_read_b64_tr_b16 v[136:137], v9 offset:4160
    ds_read_b64_tr_b16 v[138:139], v9 offset:4672
    ds_read_b64_tr_b16 v[140:141], v9 offset:4192
    ds_read_b64_tr_b16 v[142:143], v9 offset:4704
    s_waitcnt vmcnt(4)
    ds_read_b64_tr_b16 v[32:33], v9 offset:8192
    ds_read_b64_tr_b16 v[34:35], v9 offset:8704
    ds_read_b64_tr_b16 v[40:41], v9 offset:8224
    ds_read_b64_tr_b16 v[42:43], v9 offset:8736
    ds_read_b64_tr_b16 v[48:49], v9 offset:8256
    ds_read_b64_tr_b16 v[50:51], v9 offset:8768
    ds_read_b64_tr_b16 v[56:57], v9 offset:8288
    ds_read_b64_tr_b16 v[58:59], v9 offset:8800
    s_waitcnt vmcnt(0)
    ds_read_b64_tr_b16 v[36:37], v9 offset:0
    ds_read_b64_tr_b16 v[38:39], v9 offset:512
    ds_read_b64_tr_b16 v[44:45], v9 offset:32
    ds_read_b64_tr_b16 v[46:47], v9 offset:544
    ds_read_b64_tr_b16 v[52:53], v9 offset:64
    ds_read_b64_tr_b16 v[54:55], v9 offset:576
    ds_read_b64_tr_b16 v[60:61], v9 offset:96
    ds_read_b64_tr_b16 v[62:63], v9 offset:608
    s_branch L_ffn_common
L_ffn_ln:
    s_setprio 3
    s_load_dword s28, s[26:27], 0
    s_sub_u32 s33, s29, 8
    s_getreg_b32 s58, hwreg(HW_REG_XCC_ID)
    v_lshlrev_b32 v124, 3, v1
    s_lshl_b32 s34, s31, 7
    s_add_u32 s34, s34, 4096
    v_add_u32 v124, s34, v124
    v_mov_b32 v126, s58
    s_waitcnt lgkmcnt(0)
    s_add_u32 s28, s28, 2654435769
    s_and_b32 s44, s28, 0xff
    s_bfe_u32 s45, s28, 0x80008
    s_bfe_u32 s46, s28, 0x80010
    s_lshr_b32 s47, s28, 24
    s_xor_b32 s34, s28, s58
    v_mov_b32 v126, s34
    v_mov_b32 v127, s34
    s_cmp_eq_u32 s33, 0
    s_cselect_b32 s56, 0xffff, 0
    s_mov_b32 s57, 0
    s_mov_b64 exec, s[56:57]
    global_store_dwordx2 v124, v[126:127], s[26:27] sc1
    s_mov_b64 exec, -1
    s_mov_b32 m0, s38
    s_nop 0
    global_load_lds_dwordx4 v24, s[20:21] offset:0 nt
    global_load_lds_dwordx4 v25, s[20:21] offset:1024 nt
    global_load_lds_dwordx4 v26, s[20:21] offset:2048 nt
    global_load_lds_dwordx4 v27, s[20:21] offset:3072 nt
    s_add_u32 s20, s20, 40960
    s_addc_u32 s21, s21, 0
    s_add_u32 s39, s38, 4096
    s_mov_b32 m0, s39
    s_nop 0
    global_load_lds_dwordx4 v24, s[20:21] offset:0 nt
    global_load_lds_dwordx4 v25, s[20:21] offset:1024 nt
    global_load_lds_dwordx4 v26, s[20:21] offset:2048 nt
    global_load_lds_dwordx4 v27, s[20:21] offset:3072 nt
    s_add_u32 s20, s20, 40960
    s_addc_u32 s21, s21, 0
    s_add_u32 s56, s26, 4096
    s_addc_u32 s57, s27, 0
    s_xor_b32 s60, s28, s58
    s_mov_b32 s62, 0
L_fx0:
    s_add_u32 s59, s59, 1
    s_cmp_gt_u32 s59, 1048576
    s_cbranch_scc1 L_end
    s_load_dword s40, s[56:57], 0 glc
    s_load_dword s41, s[56:57], 128 glc
    s_load_dword s48, s[56:57], 256 glc
    s_load_dword s49, s[56:57], 384 glc
    s_load_dword s50, s[56:57], 512 glc
    s_load_dword s51, s[56:57], 640 glc
    s_load_dword s52, s[56:57], 768 glc
    s_load_dword s53, s[56:57], 896 glc
    s_load_dword s54, s[56:57], 1024 glc
    s_waitcnt lgkmcnt(0)
    s_mov_b32 s61, 0
    s_xor_b32 s40, s40, s60
    s_or_b32 s61, s61, s40
    s_xor_b32 s41, s41, s60
    s_or_b32 s61, s61, s41
    s_xor_b32 s48, s48, s60
    s_or_b32 s61, s61, s48
    s_xor_b32 s49, s49, s60
    s_or_b32 s61, s61, s49
    s_xor_b32 s50, s50, s60
    s_or_b32 s61, s61, s50
    s_xor_b32 s51, s51, s60
    s_or_b32 s61, s61, s51
    s_xor_b32 s52, s52, s60
    s_or_b32 s61, s61, s52
    s_xor_b32 s53, s53, s60
    s_or_b32 s61, s61, s53
    s_xor_b32 s54, s54, s60
    s_or_b32 s61, s61, s54
    s_cmp_gt_u32 s61, 7
    s_cbranch_scc1 L_fx0
    s_or_b32 s62, s62, s61
L_fx1:
    s_add_u32 s59, s59, 1
    s_cmp_gt_u32 s59, 1048576
    s_cbranch_scc1 L_end
    s_load_dword s40, s[56:57], 1152 glc
    s_load_dword s41, s[56:57], 1280 glc
    s_load_dword s48, s[56:57], 1408 glc
    s_load_dword s49, s[56:57], 1536 glc
    s_load_dword s50, s[56:57], 1664 glc
    s_load_dword s51, s[56:57], 1792 glc
    s_load_dword s52, s[56:57], 1920 glc
    s_load_dword s53, s[56:57], 2048 glc
    s_load_dword s54, s[56:57], 2176 glc
    s_waitcnt lgkmcnt(0)
    s_mov_b32 s61, 0
    s_xor_b32 s40, s40, s60
    s_or_b32 s61, s61, s40
    s_xor_b32 s41, s41, s60
    s_or_b32 s61, s61, s41
    s_xor_b32 s48, s48, s60
    s_or_b32 s61, s61, s48
    s_xor_b32 s49, s49, s60
    s_or_b32 s61, s61, s49
    s_xor_b32 s50, s50, s60
    s_or_b32 s61, s61, s50
    s_xor_b32 s51, s51, s60
    s_or_b32 s61, s61, s51
    s_xor_b32 s52, s52, s60
    s_or_b32 s61, s61, s52
    s_xor_b32 s53, s53, s60
    s_or_b32 s61, s61, s53
    s_xor_b32 s54, s54, s60
    s_or_b32 s61, s61, s54
    s_cmp_gt_u32 s61, 7
    s_cbranch_scc1 L_fx1
    s_or_b32 s62, s62, s61
L_fx2:
    s_add_u32 s59, s59, 1
    s_cmp_gt_u32 s59, 1048576
    s_cbranch_scc1 L_end
    s_load_dword s40, s[56:57], 2304 glc
    s_load_dword s41, s[56:57], 2432 glc
    s_load_dword s48, s[56:57], 2560 glc
    s_load_dword s49, s[56:57], 2688 glc
    s_load_dword s50, s[56:57], 2816 glc
    s_load_dword s51, s[56:57], 2944 glc
    s_load_dword s52, s[56:57], 3072 glc
    s_load_dword s53, s[56:57], 3200 glc
    s_load_dword s54, s[56:57], 3328 glc
    s_waitcnt lgkmcnt(0)
    s_mov_b32 s61, 0
    s_xor_b32 s40, s40, s60
    s_or_b32 s61, s61, s40
    s_xor_b32 s41, s41, s60
    s_or_b32 s61, s61, s41
    s_xor_b32 s48, s48, s60
    s_or_b32 s61, s61, s48
    s_xor_b32 s49, s49, s60
    s_or_b32 s61, s61, s49
    s_xor_b32 s50, s50, s60
    s_or_b32 s61, s61, s50
    s_xor_b32 s51, s51, s60
    s_or_b32 s61, s61, s51
    s_xor_b32 s52, s52, s60
    s_or_b32 s61, s61, s52
    s_xor_b32 s53, s53, s60
    s_or_b32 s61, s61, s53
    s_xor_b32 s54, s54, s60
    s_or_b32 s61, s61, s54
    s_cmp_gt_u32 s61, 7
    s_cbranch_scc1 L_fx2
    s_or_b32 s62, s62, s61
    v_mov_b32 v124, 0
    v_mov_b32 v125, s62
    ds_write_b32 v124, v125 offset:3136
    s_waitcnt vmcnt(0)
    ds_read_b64_tr_b16 v[32:33], v9 offset:0
    ds_read_b64_tr_b16 v[34:35], v9 offset:512
    ds_read_b64_tr_b16 v[40:41], v9 offset:32
    ds_read_b64_tr_b16 v[42:43], v9 offset:544
    ds_read_b64_tr_b16 v[48:49], v9 offset:64
    ds_read_b64_tr_b16 v[50:51], v9 offset:576
    ds_read_b64_tr_b16 v[56:57], v9 offset:96
    ds_read_b64_tr_b16 v[58:59], v9 offset:608
    ds_read_b64_tr_b16 v[36:37], v9 offset:4096
    ds_read_b64_tr_b16 v[38:39], v9 offset:4608
    ds_read_b64_tr_b16 v[44:45], v9 offset:4128
    ds_read_b64_tr_b16 v[46:47], v9 offset:4640
    ds_read_b64_tr_b16 v[52:53], v9 offset:4160
    ds_read_b64_tr_b16 v[54:55], v9 offset:4672
    ds_read_b64_tr_b16 v[60:61], v9 offset:4192
    ds_read_b64_tr_b16 v[62:63], v9 offset:4704
    s_waitcnt lgkmcnt(0)
    s_barrier
L_ffn_common:
    v_and_b32 v4, 31, v1
    v_lshrrev_b32 v5, 5, v1
    v_bfe_u32 v6, v1, 2, 1
    v_mul_u32_u24 v6, 1280, v6
    v_bfe_u32 v7, v1, 3, 2
    v_lshl_add_u32 v6, v7, 5, v6
    v_and_b32 v7, 3, v1
    v_lshl_add_u32 v6, v7, 3, v6
    v_lshl_add_u32 v6, v5, 1, v6
    s_lshl_b32 s34, s29, 7
    v_add_u32 v6, s34, v6
    v_bfe_u32 v10, v1, 2, 1
    v_mul_u32_u24 v7, 1280, v10
    v_sub_u32 v11, v6, v7
    v_lshrrev_b32 v11, 3, v11
    v_lshl_add_u32 v7, v11, 2, v7
    v_lshl_add_u32 v7, v5, 1, v7
    global_load_ushort v2, v6, s[4:5]
    global_load_ushort v3, v6, s[4:5] offset:4
    v_mul_u32_u24 v160, 5120, v5
    v_lshl_add_u32 v160, v4, 4, v160
    s_lshl_b32 s34, s29, 9
    s_add_u32 s35, s34, 16384
    v_add_u32 v160, s35, v160
    v_add_u32 v161, 10240, v160
    v_add_u32 v162, 20480, v160
    v_add_u32 v163, 30720, v160
    v_bfe_u32 v10, v1, 2, 1
    v_mul_u32_u24 v11, 1280, v10
    v_lshl_add_u32 v11, v8, 4, v11
    v_and_b32 v12, 1, v1
    v_mul_u32_u24 v13, 640, v12
    s_mul_i32 s35, s32, 160
    v_add3_u32 v11, s35, v11, v13
    v_mov_b32 v167, 0x44444444
    v_mov_b32 v13, 0xaaaaaaaa
    v_cmp_eq_u32 vcc, 1, v12
    v_or_b32 v13, v167, v13
    s_nop 0
    v_cndmask_b32 v167, v167, v13, vcc
    v_lshlrev_b32 v9, 6, v12
    v_lshlrev_b32 v12, 2, v1
    v_add_u32 v13, s34, v12
    v_lshlrev_b32 v14, 7, v10
    v_lshl_add_u32 v14, v8, 4, v14
    v_add_u32 v14, v14, v9
    v_mul_u32_u24 v164, 81920, v8
    v_and_b32 v166, 15, v1
    v_lshl_add_u32 v164, v166, 4, v164
    s_lshl_b32 s34, s29, 13
    s_lshl_b32 s35, s31, 8
    s_add_u32 s34, s34, s35
    s_add_u32 s34, s34, 1048576
    v_add_u32 v164, s34, v164
    v_mov_b32 v165, 0xff
    v_bfe_u32 v15, v1, 4, 1
    v_lshlrev_b32 v15, 7, v15
    v_lshl_add_u32 v15, v5, 4, v15
    v_bfe_u32 v9, v1, 1, 1
    v_lshl_add_u32 v15, v9, 6, v15
    v_bfe_u32 v9, v1, 2, 2
    v_lshl_add_u32 v15, v9, 2, v15
    v_and_b32 v9, 1, v1
    v_lshl_add_u32 v15, v9, 1, v15
    s_mov_b32 s42, 0
    s_mov_b32 s43, -1
    s_waitcnt vmcnt(0) lgkmcnt(0)
    v_lshlrev_b32 v2, 16, v2
    v_lshlrev_b32 v3, 16, v3
    s_cmp_ge_u32 s29, 8
    s_cbranch_scc1 L_tagged
    s_add_u32 s28, s28, 2654435769
    s_and_b32 s44, s28, 0xff
    s_bfe_u32 s45, s28, 0x80008
    s_bfe_u32 s46, s28, 0x80010
    s_lshr_b32 s47, s28, 24
L_tagged:
    s_cmp_ge_u32 s29, 8
    s_cbranch_scc1 L_nocs
    v_mov_b32 v144, 0x3f803f80
    v_mov_b32 v145, 0x3f803f80
    v_mov_b32 v146, 0x3f803f80
    v_mov_b32 v147, 0x3f803f80
    s_nop 1
    v_mfma_f32_16x16x32_bf16 v[16:19], v[144:147], v[64:67], 0
    v_mfma_f32_16x16x32_bf16 v[20:23], v[144:147], v[72:75], 0
    v_mfma_f32_16x16x32_bf16 v[24:27], v[144:147], v[80:83], 0
    v_mfma_f32_16x16x32_bf16 v[28:31], v[144:147], v[88:91], 0
    v_mfma_f32_16x16x32_bf16 v[16:19], v[144:147], v[68:71], v[16:19]
    v_mfma_f32_16x16x32_bf16 v[20:23], v[144:147], v[76:79], v[20:23]
    v_mfma_f32_16x16x32_bf16 v[24:27], v[144:147], v[84:87], v[24:27]
    v_mfma_f32_16x16x32_bf16 v[28:31], v[144:147], v[92:95], v[28:31]
    v_mfma_f32_16x16x32_bf16 v[16:19], v[144:147], v[96:99], v[16:19]
    v_mfma_f32_16x16x32_bf16 v[20:23], v[144:147], v[104:107], v[20:23]
    v_mfma_f32_16x16x32_bf16 v[24:27], v[144:147], v[112:115], v[24:27]
    v_mfma_f32_16x16x32_bf16 v[28:31], v[144:147], v[120:123], v[28:31]
    v_mfma_f32_16x16x32_bf16 v[16:19], v[144:147], v[100:103], v[16:19]
    v_mfma_f32_16x16x32_bf16 v[20:23], v[144:147], v[108:111], v[20:23]
    v_mfma_f32_16x16x32_bf16 v[24:27], v[144:147], v[116:119], v[24:27]
    v_mfma_f32_16x16x32_bf16 v[28:31], v[144:147], v[124:127], v[28:31]
    v_mfma_f32_16x16x32_bf16 v[16:19], v[144:147], v[128:131], v[16:19]
    v_mfma_f32_16x16x32_bf16 v[20:23], v[144:147], v[132:135], v[20:23]
    v_mfma_f32_16x16x32_bf16 v[24:27], v[144:147], v[136:139], v[24:27]
    v_mfma_f32_16x16x32_bf16 v[28:31], v[144:147], v[140:143], v[28:31]
    s_nop 5
    v_cndmask_b32 v16, v16, v20, s[42:43]
    ds_write_b32 v13, v16 offset:8192
    v_cndmask_b32 v24, v24, v28, s[42:43]
    ds_write_b32 v13, v24 offset:8448
    s_waitcnt lgkmcnt(0)
L_nocs:
    v_mov_b32 v4, 0
    ds_read_b32 v4, v4 offset:3136
    s_waitcnt lgkmcnt(0)
    v_readfirstlane_b32 s62, v4
    v_and_b32 v16, 1, v1
    s_lshl_b32 s34, s29, 1
    v_add_u32 v16, s34, v16
    v_lshrrev_b32 v5, 1, v1
    v_lshlrev_b32 v5, 8, v5
    v_lshl_add_u32 v5, v16, 4, v5
    s_min_u32 s35, s31, 19
    s_lshl_b32 s34, s35, 13
    s_cmp_eq_u32 s62, 0
    s_cselect_b32 s36, 262144, 0
    s_add_u32 s34, s34, s36
    s_add_u32 s34, s34, 1048576
    v_add_u32 v5, s34, v5
    v_and_b32 v17, 1, v8
    v_lshlrev_b32 v17, 1, v17
    v_lshrrev_b32 v10, 1, v8
    v_add_u32 v17, v17, v10
    v_lshl_add_u32 v17, v17, 4, v16
    s_cmp_ge_u32 s35, 10
    s_cselect_b32 s36, 10, 0
    s_cselect_b32 s37, 1280, 0
    s_sub_u32 s36, s35, s36
    s_lshl_b32 s36, s36, 6
    v_add_u32 v10, s36, v17
    v_lshrrev_b32 v9, 2, v10
    v_lshlrev_b32 v9, 2, v9
    v_bfe_u32 v18, v10, 1, 1
    v_mul_u32_u24 v18, 640, v18
    v_and_b32 v19, 1, v10
    v_lshl_add_u32 v9, v19, 1, v9
    v_add3_u32 v9, v9, v18, s37
    v_lshlrev_b32 v10, 1, v10
    v_add_u32 v10, s37, v10
    s_cmp_lt_u32 s29, 8
    s_cbranch_scc1 L_nocs2
    s_setprio 3
    s_sub_u32 s33, s29, 8
    s_mul_i32 s34, s33, 1280
    v_add_u32 v108, s34, v12
    s_lshl_b32 s34, s33, 5
    v_add_u32 v15, s34, v15
    s_lshl_b32 s34, s33, 8
    v_add_u32 v109, s34, v12
    s_lshl_b32 s34, s33, 3
    v_mov_b32 v110, s34
    v_bfe_u32 v111, v1, 4, 1
    v_lshlrev_b32 v111, 3, v111
L_nocs2:
    v_mov_b32 v6, v160
    v_mov_b32 v8, v161
    v_mov_b32 v12, v162
    v_mov_b32 v166, v163
    v_mov_b32 v16, 0
    v_mov_b32 v17, 0
    v_mov_b32 v18, 0
    v_mov_b32 v19, 0
    v_mov_b32 v20, 0
    v_mov_b32 v21, 0
    v_mov_b32 v22, 0
    v_mov_b32 v23, 0
    v_mov_b32 v24, 0
    v_mov_b32 v25, 0
    v_mov_b32 v26, 0
    v_mov_b32 v27, 0
    v_mov_b32 v28, 0
    v_mov_b32 v29, 0
    v_mov_b32 v30, 0
    v_mov_b32 v31, 0
    v_mov_b32 v144, 0
    v_mov_b32 v145, 0
    v_mov_b32 v146, 0
    v_mov_b32 v147, 0
    s_mov_b32 s48, -1
    s_mov_b32 s49, -1
    s_mov_b32 s50, -1
    s_mov_b32 s51, -1
    s_mov_b32 s52, -1
    s_mov_b32 s53, -1
    s_mov_b32 s54, -1
    s_mov_b32 s55, -1
L_ppoll:
    s_add_u32 s59, s59, 1
    s_cmp_gt_u32 s59, 1048576
    s_cbranch_scc1 L_end
    s_mov_b64 exec, s[48:49]
    global_load_dwordx4 v[148:151], v6, s[26:27] offset:0 sc1
    s_mov_b64 exec, s[50:51]
    global_load_dwordx4 v[152:155], v8, s[26:27] offset:0 sc1
    s_mov_b64 exec, s[52:53]
    global_load_dwordx4 v[156:159], v12, s[26:27] offset:0 sc1
    s_mov_b64 exec, s[54:55]
    global_load_dwordx4 v[160:163], v166, s[26:27] offset:0 sc1
    s_mov_b64 exec, s[48:49]
    s_waitcnt vmcnt(3)
    v_xor_b32 v148, s44, v148
    v_xor_b32 v149, s45, v149
    v_xor_b32 v150, s46, v150
    v_xor_b32 v151, s47, v151
    v_or3_b32 v4, v148, v149, v150
    v_or_b32 v4, v4, v151
    v_cmp_ne_u32_sdwa s[48:49], v4, 0 src0_sel:BYTE_0 src1_sel:DWORD
    s_mov_b64 exec, s[50:51]
    s_waitcnt vmcnt(2)
    v_xor_b32 v152, s44, v152
    v_xor_b32 v153, s45, v153
    v_xor_b32 v154, s46, v154
    v_xor_b32 v155, s47, v155
    v_or3_b32 v4, v152, v153, v154
    v_or_b32 v4, v4, v155
    v_cmp_ne_u32_sdwa s[50:51], v4, 0 src0_sel:BYTE_0 src1_sel:DWORD
    s_mov_b64 exec, s[52:53]
    s_waitcnt vmcnt(1)
    v_xor_b32 v156, s44, v156
    v_xor_b32 v157, s45, v157
    v_xor_b32 v158, s46, v158
    v_xor_b32 v159, s47, v159
    v_or3_b32 v4, v156, v157, v158
    v_or_b32 v4, v4, v159
    v_cmp_ne_u32_sdwa s[52:53], v4, 0 src0_sel:BYTE_0 src1_sel:DWORD
    s_mov_b64 exec, s[54:55]
    s_waitcnt vmcnt(0)
    v_xor_b32 v160, s44, v160
    v_xor_b32 v161, s45, v161
    v_xor_b32 v162, s46, v162
    v_xor_b32 v163, s47, v163
    v_or3_b32 v4, v160, v161, v162
    v_or_b32 v4, v4, v163
    v_cmp_ne_u32_sdwa s[54:55], v4, 0 src0_sel:BYTE_0 src1_sel:DWORD
    s_mov_b64 exec, -1
    s_wqm_b64 s[48:49], s[48:49]
    s_wqm_b64 s[50:51], s[50:51]
    s_wqm_b64 s[52:53], s[52:53]
    s_wqm_b64 s[54:55], s[54:55]
    s_or_b64 vcc, s[48:49], s[50:51]
    s_or_b64 vcc, vcc, s[52:53]
    s_or_b64 vcc, vcc, s[54:55]
    s_cbranch_scc1 L_ppoll
    v_pk_add_f32 v[148:149], v[148:149], v[152:153]
    v_pk_add_f32 v[150:151], v[150:151], v[154:155]
    v_pk_add_f32 v[156:157], v[156:157], v[160:161]
    v_pk_add_f32 v[158:159], v[158:159], v[162:163]
    v_pk_add_f32 v[148:149], v[148:149], v[156:157]
    v_pk_add_f32 v[150:151], v[150:151], v[158:159]
    v_mov_b32 v160, 0
    v_permlane32_swap_b32 v148, v149
    v_permlane32_swap_b32 v150, v151
    v_add_f32 v148, v148, v149
    v_add_f32 v150, v150, v151
    v_cvt_pk_bf16_f32 v4, v148, v150
    v_lshlrev_b32 v148, 16, v4
    v_and_b32 v4, 0xffff0000, v4
    v_add_f32 v148, v148, v2
    v_add_f32 v4, v4, v3
    v_cvt_pk_bf16_f32 v4, v148, v4
    ds_write_b16 v7, v4 offset:0
    ds_write_b16_d16_hi v7, v4 offset:640
    v_mov_b32 v161, 0
    v_mov_b32 v162, 0
    v_mov_b32 v163, 0
    s_cmp_lt_u32 s29, 8
    s_cbranch_scc1 L_ffn_wait
    s_waitcnt lgkmcnt(0)
    s_barrier
    ds_read_b32 v64, v108 offset:0
    ds_read_b32 v65, v108 offset:256
    ds_read_b32 v66, v108 offset:512
    ds_read_b32 v67, v108 offset:768
    ds_read_b32 v68, v108 offset:1024
    ds_read2st64_b32 v[112:113], v109 offset0:32 offset1:34
    ds_read2st64_b32 v[114:115], v109 offset0:36 offset1:38
    ds_read2st64_b32 v[116:117], v109 offset0:40 offset1:42
    ds_read2st64_b32 v[118:119], v109 offset0:44 offset1:46
    s_waitcnt lgkmcnt(4)
    v_readfirstlane_b32 s34, v64
    v_lshlrev_b32 v80, 16, v64
    v_and_b32 v81, 0xffff0000, v64
    v_lshlrev_b32 v82, 16, v65
    v_and_b32 v83, 0xffff0000, v65
    v_lshlrev_b32 v84, 16, v66
    v_and_b32 v85, 0xffff0000, v66
    v_lshlrev_b32 v86, 16, v67
    v_and_b32 v87, 0xffff0000, v67
    v_lshlrev_b32 v88, 16, v68
    v_and_b32 v89, 0xffff0000, v68
    s_lshl_b32 s34, s34, 16
    v_subrev_f32 v80, s34, v80
    v_subrev_f32 v81, s34, v81
    v_subrev_f32 v82, s34, v82
    v_subrev_f32 v83, s34, v83
    v_subrev_f32 v84, s34, v84
    v_subrev_f32 v85, s34, v85
    v_subrev_f32 v86, s34, v86
    v_subrev_f32 v87, s34, v87
    v_subrev_f32 v88, s34, v88
    v_subrev_f32 v89, s34, v89
    v_add_f32 v100, v80, v81
    v_mul_f32 v104, v80, v80
    v_fmac_f32 v104, v81, v81
    v_add_f32 v100, v100, v82
    v_fmac_f32 v104, v82, v82
    v_add_f32 v100, v100, v83
    v_fmac_f32 v104, v83, v83
    v_add_f32 v100, v100, v84
    v_fmac_f32 v104, v84, v84
    v_add_f32 v100, v100, v85
    v_fmac_f32 v104, v85, v85
    v_add_f32 v100, v100, v86
    v_fmac_f32 v104, v86, v86
    v_add_f32 v100, v100, v87
    v_fmac_f32 v104, v87, v87
    v_add_f32 v100, v100, v88
    v_fmac_f32 v104, v88, v88
    v_add_f32 v100, v100, v89
    v_fmac_f32 v104, v89, v89
    s_nop 0
    v_add_f32_dpp v100, v100, v100 row_ror:8 row_mask:0xf bank_mask:0xf
    v_add_f32_dpp v104, v104, v104 row_ror:8 row_mask:0xf bank_mask:0xf
    s_nop 0
    v_add_f32_dpp v100, v100, v100 row_ror:4 row_mask:0xf bank_mask:0xf
    v_add_f32_dpp v104, v104, v104 row_ror:4 row_mask:0xf bank_mask:0xf
    s_nop 0
    v_add_f32_dpp v100, v100, v100 row_ror:2 row_mask:0xf bank_mask:0xf
    v_add_f32_dpp v104, v104, v104 row_ror:2 row_mask:0xf bank_mask:0xf
    s_nop 0
    v_add_f32_dpp v100, v100, v100 row_ror:1 row_mask:0xf bank_mask:0xf
    v_add_f32_dpp v104, v104, v104 row_ror:1 row_mask:0xf bank_mask:0xf
    v_mov_b32 v101, v100
    v_mov_b32 v105, v104
    s_nop 0
    v_permlane16_swap_b32 v100, v101
    v_permlane16_swap_b32 v104, v105
    v_add_f32 v100, v100, v101
    v_add_f32 v104, v104, v105
    v_mov_b32 v101, v100
    v_mov_b32 v105, v104
    s_nop 0
    v_permlane32_swap_b32 v100, v101
    v_permlane32_swap_b32 v104, v105
    v_add_f32 v100, v100, v101
    v_add_f32 v104, v104, v105
    v_mul_f32 v100, 0x3acccccd, v100
    v_mul_f32 v104, 0x3acccccd, v104
    v_add_f32 v102, s34, v100
    v_fma_f32 v104, -v100, v100, v104
    v_cvt_pk_bf16_f32 v102, v102, v102
    v_max_f32 v104, 0, v104
    v_and_b32 v102, 0xffff0000, v102
    v_cvt_pk_bf16_f32 v104, v104, v104
    v_and_b32 v104, 0xffff0000, v104
    v_add_f32 v104, 0x3727c5ac, v104
    v_cvt_pk_bf16_f32 v104, v104, v104
    v_and_b32 v104, 0xffff0000, v104
    v_sqrt_f32 v104, v104
    s_nop 0
    v_cvt_pk_bf16_f32 v104, v104, v104
    v_and_b32 v104, 0xffff0000, v104
    v_rcp_f32 v103, v104
    s_nop 0
    v_fma_f32 v105, -v104, v103, 1.0
    v_fma_f32 v103, v105, v103, v103
    ds_write_b64 v110, v[102:103] offset:3072
    s_waitcnt lgkmcnt(0)
    s_barrier
    ds_read_b64 v[72:73], v111 offset:3072
    ds_read2st64_b32 v[64:65], v109 offset0:16 offset1:18
    ds_read2st64_b32 v[66:67], v109 offset0:20 offset1:22
    ds_read2st64_b32 v[68:69], v109 offset0:24 offset1:26
    ds_read2st64_b32 v[70:71], v109 offset0:28 offset1:30
    v_add_f32 v112, v112, v114
    v_add_f32 v113, v113, v115
    v_add_f32 v116, v116, v118
    v_add_f32 v117, v117, v119
    v_add_f32 v112, v112, v116
    v_add_f32 v113, v113, v117
    s_waitcnt lgkmcnt(2)
    v_pk_add_f32 v[64:65], v[64:65], v[66:67]
    v_pk_fma_f32 v[64:65], v[112:113], v[72:73], v[64:65] op_sel_hi:[1,0,1] neg_lo:[0,1,0] neg_hi:[0,1,0]
    s_waitcnt lgkmcnt(0)
    v_pk_add_f32 v[68:69], v[68:69], v[70:71]
    v_pk_add_f32 v[64:65], v[64:65], v[68:69]
    v_pk_mul_f32 v[64:65], v[64:65], v[72:73] op_sel:[0,1] op_sel_hi:[1,1]
    v_cvt_pk_bf16_f32 v64, v64, v65
    v_lshlrev_b32 v65, 16, v64
    v_mul_f32 v67, 0xbfb8aa3b, v65
    v_exp_f32 v67, v67
    v_and_b32 v66, 0xffff0000, v64
    v_add_f32 v67, 1.0, v67
    v_rcp_f32 v67, v67
    s_nop 0
    v_mul_f32 v67, v65, v67
    v_cvt_pk_bf16_f32 v67, v67, v67
    v_and_b32 v67, 0xffff0000, v67
    v_mul_f32 v67, v67, v66
    v_cvt_pk_bf16_f32 v67, v67, v67
    ds_write_b16 v15, v67 offset:2560
    s_waitcnt vmcnt(0) lgkmcnt(0)
    s_branch L_ffn_b7
L_ffn_wait:
    s_waitcnt lgkmcnt(0)
    s_barrier
    ds_read_b128 v[148:151], v11 offset:0
    ds_read_b128 v[152:155], v11 offset:64
    s_mov_b64 exec, 0xffffffff
    ds_read_b128 v[160:163], v11 offset:128
    s_mov_b64 exec, -1
    s_waitcnt lgkmcnt(2)
    v_smfmac_f32_16x16x64_bf16 v[16:19], v[148:151], v[64:71], v167
    v_smfmac_f32_16x16x64_bf16 v[20:23], v[148:151], v[72:79], v167
    v_smfmac_f32_16x16x64_bf16 v[24:27], v[148:151], v[80:87], v167
    v_smfmac_f32_16x16x64_bf16 v[28:31], v[148:151], v[88:95], v167
    s_waitcnt lgkmcnt(1)
    v_smfmac_f32_16x16x64_bf16 v[16:19], v[152:155], v[96:103], v167
    v_smfmac_f32_16x16x64_bf16 v[20:23], v[152:155], v[104:111], v167
    v_smfmac_f32_16x16x64_bf16 v[24:27], v[152:155], v[112:119], v167
    v_smfmac_f32_16x16x64_bf16 v[28:31], v[152:155], v[120:127], v167
    s_waitcnt lgkmcnt(0)
    v_smfmac_f32_16x16x64_bf16 v[16:19], v[160:163], v[128:135], v167
    v_smfmac_f32_16x16x64_bf16 v[20:23], v[160:163], v[132:139], v167
    v_smfmac_f32_16x16x64_bf16 v[24:27], v[160:163], v[136:143], v167
    v_smfmac_f32_16x16x64_bf16 v[28:31], v[160:163], v[140:147], v167
    s_nop 4
    v_add_f32 v16, v16, v17
    v_add_f32 v20, v20, v21
    v_add_f32 v24, v24, v25
    v_add_f32 v28, v28, v29
    v_cndmask_b32 v16, v16, v20, s[42:43]
    ds_write_b32 v13, v16 offset:4096
    v_cndmask_b32 v24, v24, v28, s[42:43]
    ds_write_b32 v13, v24 offset:4352
    s_waitcnt lgkmcnt(0)
    s_barrier
    v_mov_b32 v16, 0
    v_mov_b32 v17, 0
    v_mov_b32 v18, 0
    v_mov_b32 v19, 0
    v_mov_b32 v20, 0
    v_mov_b32 v21, 0
    v_mov_b32 v22, 0
    v_mov_b32 v23, 0
    v_mov_b32 v24, 0
    v_mov_b32 v25, 0
    v_mov_b32 v26, 0
    v_mov_b32 v27, 0
    v_mov_b32 v28, 0
    v_mov_b32 v29, 0
    v_mov_b32 v30, 0
    v_mov_b32 v31, 0
    ds_read_u16 v69, v9 offset:0
    v_mov_b32 v72, 0
    v_mov_b32 v73, 0
    v_mov_b32 v74, 0
    v_mov_b32 v75, 0
L_ffn_b7:
    s_add_u32 s48, s26, 262144
    s_addc_u32 s49, s27, 0
    s_cmp_eq_u32 s62, 0
    s_barrier
    ds_read_b128 v[144:147], v14 offset:2560
    s_waitcnt lgkmcnt(0)
    v_smfmac_f32_16x16x64_bf16 v[16:19], v[144:147], v[32:39], v167
    v_smfmac_f32_16x16x64_bf16 v[20:23], v[144:147], v[40:47], v167
    v_smfmac_f32_16x16x64_bf16 v[24:27], v[144:147], v[48:55], v167
    v_smfmac_f32_16x16x64_bf16 v[28:31], v[144:147], v[56:63], v167
    s_mov_b64 exec, 0xffffffff
    s_nop 3
    v_add_f32 v16, v16, v17
    v_add_f32 v20, v20, v21
    v_add_f32 v24, v24, v25
    v_add_f32 v28, v28, v29
    v_bfi_b32 v152, v165, s44, v16
    v_bfi_b32 v153, v165, s45, v20
    v_bfi_b32 v154, v165, s46, v24
    v_bfi_b32 v155, v165, s47, v28
    s_cbranch_scc0 L_gl
    global_store_dwordx4 v164, v[152:155], s[48:49]
    s_branch L_nogl
L_gl:
    global_store_dwordx4 v164, v[152:155], s[26:27] sc1
L_nogl:
    s_cmp_ge_u32 s29, 8
    s_cselect_b32 s34, 99, s31
    s_cmp_lt_u32 s34, 20
    s_cbranch_scc1 L_red
    s_endpgm
L_red:
    s_mov_b64 exec, -1
    s_lshl_b32 s36, s31, 3
    s_add_u32 s36, s36, s29
    v_lshlrev_b32 v69, 16, v69
    s_mov_b32 s56, 0x00030003
    s_mov_b32 s57, 0x00030003
    s_mov_b32 s40, -1
    s_mov_b32 s41, 0x003fffff
L_r3poll:
    s_add_u32 s59, s59, 1
    s_cmp_gt_u32 s59, 1048576
    s_cbranch_scc1 L_end
    s_mov_b64 exec, s[40:41]
    global_load_dwordx4 v[72:75], v5, s[26:27] offset:0 sc1
    s_mov_b64 exec, s[40:41]
    s_waitcnt vmcnt(0)
    v_xor_b32 v72, s44, v72
    v_xor_b32 v73, s45, v73
    v_xor_b32 v74, s46, v74
    v_xor_b32 v75, s47, v75
    v_or3_b32 v4, v72, v73, v74
    v_or_b32 v4, v4, v75
    v_cmp_ne_u32_sdwa s[40:41], v4, 0 src0_sel:BYTE_0 src1_sel:DWORD
    s_mov_b64 exec, -1
    s_wqm_b64 s[40:41], s[40:41]
    s_and_b32 s41, s41, 0x003fffff
    s_or_b32 vcc_lo, s40, s41
    s_cbranch_scc1 L_r3poll
    v_permlane32_swap_b32 v72, v73
    v_permlane32_swap_b32 v74, v75
    v_add_f32 v72, v72, v73
    v_add_f32 v74, v74, v75
    s_nop 1
    v_permlane16_swap_b32 v72, v74
    v_add_f32 v72, v72, v74
    s_nop 1
    v_add_f32_dpp v72, v72, v72 row_ror:8 row_mask:0xf bank_mask:0xf
    s_nop 1
    v_add_f32_dpp v72, v72, v72 row_ror:4 row_mask:0xf bank_mask:0xf
    s_nop 1
    v_add_f32_dpp v72, v72, v72 row_ror:2 row_mask:0xf bank_mask:0xf
    v_cvt_pk_bf16_f32 v72, v72, v72
    v_and_b32 v72, 0xffff0000, v72
    v_add_f32 v72, v72, v69
    v_cvt_pk_bf16_f32 v72, v72, v72
    s_mov_b64 exec, s[56:57]
    global_store_short v10, v72, s[22:23]
    s_cmp_lg_u32 s36, 0
    s_cbranch_scc1 L_red_end
    s_mov_b64 exec, 1
    v_mov_b32 v17, 0
    v_mov_b32 v18, s28
    global_store_dword v17, v18, s[26:27] sc1
L_red_end:
    s_endpgm
L_warm:
    s_sub_u32 s34, s31, 27
    s_mul_i32 s34, s34, 10
    s_add_u32 s34, s34, s29
    v_lshlrev_b32 v3, 4, v1
    s_min_u32 s35, s34, 39
    s_lshl_b32 s35, s35, 12
    s_add_u32 s35, s35, 1310720
    v_add_u32 v4, s35, v3
    s_waitcnt lgkmcnt(0)
    global_load_dwordx4 v[8:11], v4, s[26:27] offset:0 sc1
    global_load_dwordx4 v[8:11], v4, s[26:27] offset:1024 sc1
    global_load_dwordx4 v[8:11], v4, s[26:27] offset:2048 sc1
    global_load_dwordx4 v[8:11], v4, s[26:27] offset:3072 sc1
    s_endpgm
L_end:
    s_endpgm
.fill (20480 + 256 - (. - L_start)) / 4, 4, 0xBF810000
.section .rodata,"a"
.p2align 6
.amdhsa_kernel sequential_preLN__sliding_block_cached__swiglu_ffn__decode_kernel
  .amdhsa_next_free_vgpr 168
  .amdhsa_next_free_sgpr 102
  .amdhsa_accum_offset 168
  .amdhsa_group_segment_fixed_size 0
  .amdhsa_kernarg_size 96
  .amdhsa_user_sgpr_count 2
  .amdhsa_user_sgpr_kernarg_segment_ptr 1
  .amdhsa_system_sgpr_workgroup_id_x 1
  .amdhsa_float_denorm_mode_32 3
.end_amdhsa_kernel
```
